```python
import torch

def _softmax(x, axis=-1):
    return torch.softmax(x, dim=axis)
def _gelu(x):
    return torch.nn.functional.gelu(x, approximate="tanh")
def _silu(x):
    return torch.nn.functional.silu(x)
def _sigmoid(x):
    return torch.sigmoid(x)
def _layernorm(x, axis=-1, eps=1e-5):
    m = x.mean(dim=axis, keepdim=True)
    v = x.var(dim=axis, keepdim=True, unbiased=False)
    return (x - m) / torch.sqrt(v + eps)
def _scatter_add(tgt, idx, src, axis=0):
    return tgt.clone().index_add_(axis, idx, src)
def _segment_sum(src, seg, n):
    out = torch.zeros((n,) + src.shape[1:], dtype=src.dtype)
    return out.index_add_(0, seg, src)
def _pad(x, pw):
    flat = tuple(v for pair in reversed(pw) for v in pair)
    return torch.nn.functional.pad(x, flat)

kernel_name = 'sequential_preLN__spectral_fnet__dense_activation_squared_relu__prompt'

def setup_inputs():

    _w = (lambda a: (lambda t: t.to(torch.bfloat16) if t.is_floating_point() else t)(torch.as_tensor(a)))
    def _A_setup():
        B, S, D = 1, 2048, 512
        ns = torch.arange(S)[:, None] * torch.arange(S)[None, :]
        nd = torch.arange(D)[:, None] * torch.arange(D)[None, :]
        Ws_re = torch.cos(-2.0 * torch.pi * ns / S).to(float)
        Ws_im = torch.sin(-2.0 * torch.pi * ns / S).to(float)
        Wd_re = torch.cos(-2.0 * torch.pi * nd / D).to(float)
        Wd_im = torch.sin(-2.0 * torch.pi * nd / D).to(float)
        return {
            "x": _w((lambda *s: torch.randn(*s, dtype=torch.bfloat16) * 0.05)(B, S, D)),
            "dft_seq_re": _w(Ws_re),
            "dft_seq_im": _w(Ws_im),
            "dft_hid_re": _w(Wd_re),
            "dft_hid_im": _w(Wd_im),
        }
    _A_in = _A_setup()

    def _B_setup():
        B, S, D, F = 1, 2048, 512, 1792
        return {
            "x": _w((lambda *s: torch.randn(*s, dtype=torch.bfloat16) * 0.05)(B, S, D)),
            "w1": _w((lambda *s: torch.randn(*s, dtype=torch.bfloat16) * 0.2)(D, F)),
            "b1": _w((lambda *s: torch.randn(*s, dtype=torch.bfloat16) * 0.2)(F)),
            "w2": _w((lambda *s: torch.randn(*s, dtype=torch.bfloat16) * 0.2)(F, D)),
            "b2": _w((lambda *s: torch.randn(*s, dtype=torch.bfloat16) * 0.2)(D)),
        }
    _B_in = _B_setup()

    return {
        "A_x": _A_in["x"],
        "A_dft_seq_re": _A_in["dft_seq_re"],
        "A_dft_seq_im": _A_in["dft_seq_im"],
        "A_dft_hid_re": _A_in["dft_hid_re"],
        "A_dft_hid_im": _A_in["dft_hid_im"],
        "B_x": _B_in["x"],
        "B_w1": _B_in["w1"],
        "B_b1": _B_in["b1"],
        "B_w2": _B_in["w2"],
        "B_b2": _B_in["b2"],
    }

def reference(A_x, A_dft_seq_re, A_dft_seq_im, A_dft_hid_re, A_dft_hid_im, B_x, B_w1, B_b1, B_w2, B_b2):
    def _A_ref(x, dft_seq_re, dft_seq_im, dft_hid_re, dft_hid_im):
        a = torch.einsum("bsd,ed->bse", x, dft_hid_re)
        b = torch.einsum("bsd,ed->bse", x, dft_hid_im)
        y = torch.einsum("ts,bse->bte", dft_seq_re, a) - torch.einsum("ts,bse->bte", dft_seq_im, b)
        return y

    def _B_ref(x, w1, b1, w2, b2):
        h = torch.einsum("bsd,df->bsf", x, w1) + b1
        zero = torch.zeros_like(h)
        r = torch.where(h > zero, h, zero)
        h = r * r
        out = torch.einsum("bsf,fd->bsd", h, w2) + b2
        return out

    x = A_x
    h = x + _A_ref(_layernorm(x, axis=-1), A_dft_seq_re, A_dft_seq_im, A_dft_hid_re, A_dft_hid_im)
    h2 = h + _B_ref(_layernorm(h, axis=-1), B_w1, B_b1, B_w2, B_b2)
    return h2
```

```asm
; @launch grid=(256,1,1) block=(256,1,1) lds=163840
.amdgcn_target "amdgcn-amd-amdhsa--gfx950"
.text
.globl sequential_preLN__spectral_fnet__dense_activation_squared_relu__prompt_kernel
.p2align 12
.p2align 8
.type sequential_preLN__spectral_fnet__dense_activation_squared_relu__prompt_kernel,@function
sequential_preLN__spectral_fnet__dense_activation_squared_relu__prompt_kernel:
    s_cmp_ge_u32 s2, 256
    s_cbranch_scc1 L_end
    s_load_dwordx2 s[8:9], s[0:1], 0
    s_load_dwordx2 s[24:25], s[0:1], 96
    s_load_dwordx2 s[12:13], s[0:1], 48
    s_load_dwordx2 s[16:17], s[0:1], 64
    s_load_dwordx2 s[28:29], s[0:1], 56
    s_load_dwordx2 s[32:33], s[0:1], 72
    s_load_dwordx2 s[20:21], s[0:1], 80
    s_getpc_b64 s[60:61]
L_pc0:
    s_lshr_b32 s4, s2, 3
    s_lshl_b32 s4, s4, 10
    v_lshl_add_u32 v7, v0, 2, s4
    v_min_u32 v7, L_end-L_pc0, v7
    global_load_dword v183, v7, s[60:61]
    v_lshrrev_b32 v6, 6, v0
    v_and_b32 v0, 63, v0
    v_readfirstlane_b32 s3, v6
    v_and_b32 v1, 15, v0
    v_lshrrev_b32 v2, 4, v0
    v_lshlrev_b32 v3, 4, v0
    v_lshlrev_b32 v14, 7, v0
    s_lshr_b32 s39, s2, 3
    s_and_b32 s5, s2, 1
    s_and_b32 s41, s39, 3
    s_lshl2_add_u32 s41, s5, s41
    s_and_b32 s5, s2, 6
    s_lshr_b32 s38, s39, 3
    s_lshl1_add_u32 s40, s5, s38
    s_sub_u32 s5, 32, s40
    s_cmp_eq_u32 s40, 0
    s_cselect_b32 s5, 16, s5
    s_bitcmp1_b32 s39, 2
    s_cselect_b32 s40, s5, s40
    s_lshl_b32 s47, s3, 14
    s_and_b32 s43, s3, 1
    s_lshl2_add_u32 s44, s39, s3
    s_lshl_b32 s4, s41, 7
    s_and_b32 s5, s4, 0x200
    s_add_u32 s6, s4, 0
    s_and_b32 s6, s6, 0x180
    s_or_b32 s48, s6, s5
    s_add_u32 s6, s4, 128
    s_and_b32 s6, s6, 0x180
    s_or_b32 s49, s6, s5
    s_add_u32 s6, s4, 256
    s_and_b32 s6, s6, 0x180
    s_or_b32 s50, s6, s5
    s_add_u32 s6, s4, 384
    s_and_b32 s6, s6, 0x180
    s_or_b32 s51, s6, s5
    s_mov_b32 s10, 2097152
    s_mov_b32 s11, 0x20000
    s_mov_b32 s26, 33554432
    s_mov_b32 s27, 0x20000
    s_mov_b32 s18, 1835008
    s_mov_b32 s19, 0x20000
    s_mov_b32 s14, 1835008
    s_mov_b32 s15, 0x20000
    s_mov_b32 s30, 3584
    s_mov_b32 s31, 0x20000
    s_mov_b32 s34, 1024
    s_mov_b32 s35, 0x20000
    s_mov_b32 s22, 2097152
    s_mov_b32 s23, 0x20000
    s_and_b32 s4, s3, 2
    s_lshl4_add_u32 s4, s4, s43
    s_lshl_b32 s4, s4, 5
    s_add_u32 s4, s4, s40
    s_lshl_b32 s4, s4, 10
    v_lshrrev_b32 v12, 3, v0
    v_and_b32 v13, 7, v0
    v_xor_b32 v13, v13, v2
    v_lshlrev_b32 v13, 4, v13
    v_lshl_add_u32 v6, v12, 16, v13
    v_add_u32 v184, s4, v6
    v_xor_b32 v6, 64, v184
    v_add_u32 v185, 523264, v6
    s_lshl_b32 s4, s41, 5
    v_lshrrev_b32 v6, 2, v1
    v_and_b32 v7, 3, v1
    v_lshl_add_u32 v6, v6, 3, v7
    v_add_u32 v6, s4, v6
    v_add_u32 v7, 4, v6
    v_cmp_eq_u32 vcc, 0, v6
    v_mov_b32 v8, 0x100
    s_nop 0
    v_cndmask_b32 v6, v6, v8, vcc
    v_cvt_f32_u32 v6, v6
    v_cvt_f32_u32 v7, v7
    v_mul_f32 v6, 0x3b000000, v6
    v_mul_f32 v7, 0x3b000000, v7
    s_add_u32 s4, s3, s41
    s_and_b32 s4, s4, 3
    s_lshl_b32 s4, s4, 6
    v_lshl_add_u32 v8, v2, 3, s4
    v_cvt_f32_u32 v8, v8
    v_add_f32 v9, 0x42000000, v8
    s_mul_i32 s4, s3, 20480
    s_add_u32 s4, s4, 65536
    v_add_u32 v10, s4, v3
    v_mul_f32 v16, v6, v8
    v_add_f32 v17, v16, v6
    v_cos_f32 v18, v6
    v_cos_f32 v24, v16
    v_sin_f32 v32, v16
    v_cos_f32 v25, v17
    v_sin_f32 v33, v17
    v_add_f32 v18, v18, v18
    v_fma_f32 v26, v18, v25, -v24
    v_fma_f32 v34, v18, v33, -v32
    v_fma_f32 v27, v18, v26, -v25
    v_fma_f32 v35, v18, v34, -v33
    v_fma_f32 v28, v18, v27, -v26
    v_fma_f32 v36, v18, v35, -v34
    v_fma_f32 v29, v18, v28, -v27
    v_fma_f32 v37, v18, v36, -v35
    v_fma_f32 v30, v18, v29, -v28
    v_fma_f32 v38, v18, v37, -v36
    v_fma_f32 v31, v18, v30, -v29
    v_fma_f32 v39, v18, v38, -v37
    v_cvt_pk_bf16_f32 v40, v24, v25
    v_cvt_pk_bf16_f32 v41, v26, v27
    v_cvt_pk_bf16_f32 v42, v28, v29
    v_cvt_pk_bf16_f32 v43, v30, v31
    v_cvt_pk_bf16_f32 v44, v32, v33
    v_cvt_pk_bf16_f32 v45, v34, v35
    v_cvt_pk_bf16_f32 v46, v36, v37
    v_cvt_pk_bf16_f32 v47, v38, v39
    ds_write_b128 v10, v[40:43] offset:0
    ds_write_b128 v10, v[44:47] offset:1024
    s_mov_b32 s6, 13660160
    s_waitcnt lgkmcnt(0)
    s_add_u32 m0, s47, 0
    s_nop 0
    buffer_load_dwordx4 v184, s[8:11], s48 offen lds
    buffer_load_dwordx4 v185, s[8:11], s48 offen offset:1024 lds
    buffer_load_dwordx2 v[4:5], off, s[24:27], s6 sc1
    s_add_u32 m0, s47, 4096
    s_nop 0
    buffer_load_dwordx4 v184, s[8:11], s49 offen lds
    buffer_load_dwordx4 v185, s[8:11], s49 offen offset:1024 lds
    s_add_u32 m0, s47, 8192
    s_nop 0
    buffer_load_dwordx4 v184, s[8:11], s50 offen lds
    buffer_load_dwordx4 v185, s[8:11], s50 offen offset:1024 lds
    s_add_u32 m0, s47, 12288
    s_nop 0
    buffer_load_dwordx4 v184, s[8:11], s51 offen lds
    buffer_load_dwordx4 v185, s[8:11], s51 offen offset:1024 lds
    s_add_u32 m0, s47, 2048
    s_xor_b32 s46, s48, 0x200
    buffer_load_dwordx4 v184, s[8:11], s46 offen lds
    buffer_load_dwordx4 v185, s[8:11], s46 offen offset:1024 lds
    s_mov_b32 s0, s47
    s_mul_i32 s1, s3, 20480
    s_add_u32 s1, s1, 65536
    s_add_u32 s42, s40, 1024
    s_cmp_eq_u32 s40, 0
    s_cselect_b32 s42, 32, s42
    v_mul_f32 v48, v7, v8
    v_add_f32 v49, v48, v7
    v_cos_f32 v50, v7
    v_cos_f32 v56, v48
    v_sin_f32 v64, v48
    v_cos_f32 v57, v49
    v_sin_f32 v65, v49
    v_add_f32 v50, v50, v50
    v_fma_f32 v58, v50, v57, -v56
    v_fma_f32 v66, v50, v65, -v64
    v_fma_f32 v59, v50, v58, -v57
    v_fma_f32 v67, v50, v66, -v65
    v_fma_f32 v60, v50, v59, -v58
    v_fma_f32 v68, v50, v67, -v66
    v_fma_f32 v61, v50, v60, -v59
    v_fma_f32 v69, v50, v68, -v67
    v_fma_f32 v62, v50, v61, -v60
    v_fma_f32 v70, v50, v69, -v68
    v_fma_f32 v63, v50, v62, -v61
    v_fma_f32 v71, v50, v70, -v69
    v_cvt_pk_bf16_f32 v72, v56, v57
    v_cvt_pk_bf16_f32 v73, v58, v59
    v_cvt_pk_bf16_f32 v74, v60, v61
    v_cvt_pk_bf16_f32 v75, v62, v63
    v_cvt_pk_bf16_f32 v76, v64, v65
    v_cvt_pk_bf16_f32 v77, v66, v67
    v_cvt_pk_bf16_f32 v78, v68, v69
    v_cvt_pk_bf16_f32 v79, v70, v71
    v_mul_f32 v16, v6, v9
    v_add_f32 v17, v16, v6
    v_cos_f32 v24, v16
    v_sin_f32 v32, v16
    v_cos_f32 v25, v17
    v_sin_f32 v33, v17
    ds_write_b128 v10, v[72:75] offset:2048
    v_fma_f32 v26, v18, v25, -v24
    v_fma_f32 v34, v18, v33, -v32
    v_fma_f32 v27, v18, v26, -v25
    v_fma_f32 v35, v18, v34, -v33
    v_fma_f32 v28, v18, v27, -v26
    ds_write_b128 v10, v[76:79] offset:3072
    v_fma_f32 v36, v18, v35, -v34
    v_fma_f32 v29, v18, v28, -v27
    v_fma_f32 v37, v18, v36, -v35
    v_fma_f32 v30, v18, v29, -v28
    v_fma_f32 v38, v18, v37, -v36
    v_fma_f32 v31, v18, v30, -v29
    v_fma_f32 v39, v18, v38, -v37
    v_cvt_pk_bf16_f32 v40, v24, v25
    v_cvt_pk_bf16_f32 v41, v26, v27
    v_cvt_pk_bf16_f32 v42, v28, v29
    v_cvt_pk_bf16_f32 v43, v30, v31
    v_cvt_pk_bf16_f32 v44, v32, v33
    v_cvt_pk_bf16_f32 v45, v34, v35
    v_cvt_pk_bf16_f32 v46, v36, v37
    v_cvt_pk_bf16_f32 v47, v38, v39
    v_mul_f32 v48, v7, v9
    v_add_f32 v49, v48, v7
    v_cos_f32 v56, v48
    v_sin_f32 v64, v48
    v_cos_f32 v57, v49
    v_sin_f32 v65, v49
    ds_write_b128 v10, v[40:43] offset:4096
    v_fma_f32 v58, v50, v57, -v56
    v_fma_f32 v66, v50, v65, -v64
    v_fma_f32 v59, v50, v58, -v57
    v_fma_f32 v67, v50, v66, -v65
    v_fma_f32 v60, v50, v59, -v58
    ds_write_b128 v10, v[44:47] offset:5120
    v_fma_f32 v68, v50, v67, -v66
    v_fma_f32 v61, v50, v60, -v59
    v_fma_f32 v69, v50, v68, -v67
    v_fma_f32 v62, v50, v61, -v60
    v_fma_f32 v70, v50, v69, -v68
    v_fma_f32 v63, v50, v62, -v61
    v_fma_f32 v71, v50, v70, -v69
    v_cvt_pk_bf16_f32 v72, v56, v57
    v_cvt_pk_bf16_f32 v73, v58, v59
    v_cvt_pk_bf16_f32 v74, v60, v61
    v_cvt_pk_bf16_f32 v75, v62, v63
    v_cvt_pk_bf16_f32 v76, v64, v65
    v_cvt_pk_bf16_f32 v77, v66, v67
    v_cvt_pk_bf16_f32 v78, v68, v69
    v_cvt_pk_bf16_f32 v79, v70, v71
    s_mov_b32 s6, 0xffff
    s_cmp_ge_u32 s3, 2
    ds_write_b128 v10, v[72:75] offset:6144
    s_cselect_b32 s4, s42, s40
    s_cselect_b32 s5, 0, 0x3e800000
    s_cselect_b32 s6, 0xffff0000, s6
    s_cmp_eq_u32 s40, 0
    s_cselect_b32 s5, s5, 0x3e800000
    s_cselect_b32 s6, s6, -1
    ds_write_b128 v10, v[76:79] offset:7168
    v_lshl_add_u32 v11, v1, 6, s4
    v_cmp_eq_u32 vcc, 0, v11
    v_cvt_f32_u32 v11, v11
    v_mul_f32 v11, 0x3a000000, v11
    v_lshlrev_b32 v6, 15, v2
    v_and_b32 v6, 0x8000, v6
    v_cndmask_b32 v7, 0, v6, vcc
    s_lshl1_add_u32 s4, s43, s41
    s_lshl_b32 s4, s4, 3
    v_add_u32 v8, s4, v2
    v_add_u32 v6, 0, v8
    v_and_b32 v6, 31, v6
    v_cvt_f32_u32 v6, v6
    v_mul_f32 v80, v6, v11
    v_add_f32 v81, s5, v80
    v_add_u32 v6, 4, v8
    v_and_b32 v6, 31, v6
    v_cvt_f32_u32 v6, v6
    v_mul_f32 v82, v6, v11
    v_add_f32 v83, s5, v82
    v_add_u32 v6, 8, v8
    v_and_b32 v6, 31, v6
    v_cvt_f32_u32 v6, v6
    v_mul_f32 v84, v6, v11
    v_add_f32 v85, s5, v84
    v_add_u32 v6, 12, v8
    v_and_b32 v6, 31, v6
    v_cvt_f32_u32 v6, v6
    v_mul_f32 v86, v6, v11
    v_add_f32 v87, s5, v86
    v_cos_f32 v88, v80
    v_sin_f32 v96, v80
    v_cos_f32 v89, v81
    v_sin_f32 v97, v81
    v_cos_f32 v90, v82
    v_sin_f32 v98, v82
    v_cos_f32 v91, v83
    v_sin_f32 v99, v83
    v_cos_f32 v92, v84
    v_sin_f32 v100, v84
    v_cos_f32 v93, v85
    v_sin_f32 v101, v85
    v_cos_f32 v94, v86
    v_sin_f32 v102, v86
    v_cos_f32 v95, v87
    v_sin_f32 v103, v87
    v_cvt_pk_bf16_f32 v104, v88, v89
    v_cvt_pk_bf16_f32 v109, v96, v97
    v_and_b32 v104, s6, v104
    v_and_b32 v109, s6, v109
    v_xor_b32 v108, v7, v104
    v_xor_b32 v105, 0x80008000, v109
    v_cvt_pk_bf16_f32 v106, v90, v91
    v_cvt_pk_bf16_f32 v111, v98, v99
    v_and_b32 v106, s6, v106
    v_and_b32 v111, s6, v111
    v_xor_b32 v110, v7, v106
    v_xor_b32 v107, 0x80008000, v111
    v_cvt_pk_bf16_f32 v112, v92, v93
    v_cvt_pk_bf16_f32 v117, v100, v101
    v_and_b32 v112, s6, v112
    v_and_b32 v117, s6, v117
    v_xor_b32 v116, v7, v112
    v_xor_b32 v113, 0x80008000, v117
    v_cvt_pk_bf16_f32 v114, v94, v95
    v_cvt_pk_bf16_f32 v119, v102, v103
    v_and_b32 v114, s6, v114
    v_and_b32 v119, s6, v119
    v_xor_b32 v118, v7, v114
    v_xor_b32 v115, 0x80008000, v119
    v_sub_u32 v7, 15, v12
    v_lshl_add_u32 v148, v7, 16, v13
    v_xor_b32 v149, 524352, v148
    s_sub_u32 s52, 1088, s40
    ds_write_b128 v10, v[104:107] offset:8192
    s_lshl_b32 s52, s52, 10
    s_sub_u32 s53, 1088, s42
    s_lshl_b32 s53, s53, 10
    s_lshl_b32 s54, s3, 7
    s_sub_u32 s55, 896, s54
    ds_write_b128 v10, v[108:111] offset:9216
    v_add_u32 v6, s52, v148
    v_lshrrev_b32 v7, 1, v6
    v_and_b32 v7, 1048576, v7
    v_sub_u32 v150, v6, v7
    v_and_b32 v151, 2097151, v6
    ds_write_b128 v10, v[112:115] offset:10240
    v_mov_b32 v6, s40
    v_mov_b32 v7, s42
    v_and_b32 v8, 1, v2
    v_cmp_eq_u32 vcc, 1, v8
    ds_write_b128 v10, v[116:119] offset:11264
    v_add_u32 v10, 65536, v3
    v_add_u32 v11, 106496, v3
    v_cndmask_b32 v6, v6, v7, vcc
    v_lshl_add_u32 v190, v1, 6, v6
    v_lshrrev_b32 v6, 1, v1
    v_xor_b32 v6, v6, v2
    v_lshlrev_b32 v6, 4, v6
    v_lshl_add_u32 v15, v1, 7, v6
    v_add_u32 v186, s0, v15
    v_xor_b32 v187, 64, v186
    s_waitcnt lgkmcnt(0)
    s_barrier
    ds_read_b128 a[0:3], v10 offset:0
    ds_read_b128 a[4:7], v10 offset:1024
    ds_read_b128 a[8:11], v10 offset:2048
    ds_read_b128 a[12:15], v10 offset:3072
    ds_read_b128 a[16:19], v10 offset:4096
    ds_read_b128 a[20:23], v10 offset:5120
    ds_read_b128 a[24:27], v10 offset:6144
    ds_read_b128 a[28:31], v10 offset:7168
    s_add_u32 m0, s47, 6144
    s_xor_b32 s46, s49, 0x200
    buffer_load_dwordx4 v184, s[8:11], s46 offen lds
    buffer_load_dwordx4 v185, s[8:11], s46 offen offset:1024 lds
    s_add_u32 m0, s47, 10240
    s_xor_b32 s46, s50, 0x200
    buffer_load_dwordx4 v184, s[8:11], s46 offen lds
    buffer_load_dwordx4 v185, s[8:11], s46 offen offset:1024 lds
    s_add_u32 m0, s47, 14336
    s_xor_b32 s46, s51, 0x200
    buffer_load_dwordx4 v184, s[8:11], s46 offen lds
    buffer_load_dwordx4 v185, s[8:11], s46 offen offset:1024 lds
    s_mov_b64 exec, 0
    s_cmp_eq_u32 s3, 0
    s_cbranch_scc1 L_pad1
    s_cmp_eq_u32 s3, 1
    s_cbranch_scc1 L_pad2
L_retA:
    s_mov_b64 exec, -1
    s_mov_b32 vcc_lo, 0x33333333
    s_mov_b32 vcc_hi, 0xcccccccc
    v_mov_b32 v144, 0x3f803f80
    v_cndmask_b32 v144, 0, v144, vcc
    v_and_b32 v191, 1, v0
    v_mov_b32 v145, v144
    v_mul_u32_u24 v191, 0xaaaa, v191
    v_mov_b64 v[146:147], v[144:145]
    v_or_b32 v191, 0x4444, v191
    v_mov_b64 v[168:169], 0
    v_mov_b64 v[170:171], 0
    s_waitcnt vmcnt(15)
    ds_read_b128 v[16:19], v186 offset:0
    ds_read_b128 v[20:23], v187 offset:0
    s_cmp_lg_u32 s3, 0
    s_waitcnt vmcnt(12)
    ds_read_b128 v[24:27], v186 offset:4096
    ds_read_b128 v[28:31], v187 offset:4096
    v_add_u32 v4, 0x9e3779b0, v4
    v_add_u32 v5, 0x7f4a7c15, v5
    s_cbranch_scc1 L_nfx_1
    s_getreg_b32 s4, hwreg(HW_REG_XCC_ID)
    s_and_b32 s4, s4, 15
    v_add_u32 v180, s4, v4
    v_mov_b32 v181, v5
    s_lshl3_add_u32 s4, s40, s41
    s_lshl_b32 s4, s4, 7
    s_add_u32 s4, s4, 13664256
    s_mov_b64 exec, 1
    buffer_store_dwordx2 v[180:181], off, s[24:27], s4 sc1
    s_mov_b64 exec, -1
L_nfx_1:
    s_add_u32 m0, s1, 17408
    s_add_u32 s46, s53, s54
    buffer_load_dwordx4 v149, s[8:11], s46 offen lds
    s_add_u32 m0, s1, 16384
    s_nop 0
    buffer_load_dwordx4 v148, s[8:11], s46 offen lds
    s_add_u32 m0, s1, 19456
    s_add_u32 s46, s53, s55
    buffer_load_dwordx4 v149, s[8:11], s46 offen lds
    s_waitcnt vmcnt(13)
    ds_read_b128 v[32:35], v186 offset:8192
    s_waitcnt lgkmcnt(3)
    v_mfma_f32_16x16x32_bf16 v[172:175], v[16:19], v[16:19], 0
    s_add_u32 m0, s1, 18432
    ds_read_b128 v[36:39], v187 offset:8192
    ds_read_b128 a[32:35], v10 offset:20480
    v_mfma_f32_16x16x32_bf16 v[172:175], v[20:23], v[20:23], v[172:175]
    buffer_load_dwordx4 v148, s[8:11], s46 offen lds
    v_smfmac_f32_16x16x64_bf16 v[168:171], v[144:147], v[16:23], v191
    s_add_u32 m0, s1, 13312
    s_add_u32 s46, s52, s54
    ds_read_b128 a[36:39], v10 offset:21504
    v_mfma_f32_16x16x32_bf16 v[224:227], v[16:19], a[0:3], 0
    buffer_load_dwordx4 v149, s[8:11], s46 offen lds
    v_mfma_f32_16x16x32_bf16 v[228:231], v[16:19], a[4:7], 0
    s_add_u32 m0, s1, 12288
    ds_read_b128 a[40:43], v10 offset:22528
    ds_read_b128 a[44:47], v10 offset:23552
    v_mfma_f32_16x16x32_bf16 v[232:235], v[16:19], a[8:11], 0
    buffer_load_dwordx4 v150, s[8:11], s54 offen lds
    v_mfma_f32_16x16x32_bf16 v[236:239], v[16:19], a[12:15], 0
    s_add_u32 m0, s1, 15360
    ds_read_b128 a[48:51], v10 offset:24576
    s_add_u32 s46, s52, s55
    v_mfma_f32_16x16x32_bf16 v[224:227], v[20:23], a[16:19], v[224:227]
    buffer_load_dwordx4 v149, s[8:11], s46 offen lds
    v_mfma_f32_16x16x32_bf16 v[228:231], v[20:23], a[20:23], v[228:231]
    s_add_u32 m0, s1, 14336
    ds_read_b128 a[52:55], v10 offset:25600
    v_and_b32 v6, 1, v0
    v_mfma_f32_16x16x32_bf16 v[232:235], v[20:23], a[24:27], v[232:235]
    buffer_load_dwordx4 v151, s[8:11], s55 offen lds
    v_mfma_f32_16x16x32_bf16 v[236:239], v[20:23], a[28:31], v[236:239]
    s_waitcnt vmcnt(16)
    ds_read_b128 v[40:43], v186 offset:12288
    s_waitcnt lgkmcnt(9)
    v_mfma_f32_16x16x32_bf16 v[172:175], v[24:27], v[24:27], v[172:175]
    s_lshr_b32 s59, s41, 2
    ds_read_b128 v[44:47], v187 offset:12288
    v_lshlrev_b32 v6, 31, v6
    v_mfma_f32_16x16x32_bf16 v[172:175], v[28:31], v[28:31], v[172:175]
    s_waitcnt lgkmcnt(7)
    v_or_b32 v176, 1.0, v6
    v_mul_u32_u24 v182, 1536, v2
    v_smfmac_f32_16x16x64_bf16 v[168:171], v[144:147], v[24:31], v191
    s_lshl3_add_u32 s59, s44, s59
    s_mul_i32 s59, s59, 1792
    v_add_u32 v182, v182, v14
    v_mfma_f32_16x16x32_bf16 v[224:227], v[24:27], a[32:35], v[224:227]
    s_mov_b32 exec_lo, 0x3fff3fff
    s_mov_b32 exec_hi, 0x3fff3fff
    buffer_load_dword v183, v182, s[12:15], s59 offen
    s_mov_b64 exec, -1
    ds_read_b128 a[56:59], v10 offset:26624
    s_waitcnt lgkmcnt(7)
    v_mfma_f32_16x16x32_bf16 v[228:231], v[24:27], a[36:39], v[228:231]
    s_waitcnt lgkmcnt(6)
    ds_read_b128 a[60:63], v10 offset:27648
    ds_read_b128 a[64:67], v11 offset:0
    v_mfma_f32_16x16x32_bf16 v[232:235], v[24:27], a[40:43], v[232:235]
    s_cmp_lt_u32 s41, 4
    ds_read_b128 a[68:71], v11 offset:1024
    s_waitcnt lgkmcnt(8)
    v_mfma_f32_16x16x32_bf16 v[236:239], v[24:27], a[44:47], v[236:239]
    s_cselect_b64 vcc, -1, 0
    v_cndmask_b32 v177, 1.0, v176, vcc
    s_waitcnt lgkmcnt(7)
    v_mfma_f32_16x16x32_bf16 v[224:227], v[28:31], a[48:51], v[224:227]
    s_waitcnt lgkmcnt(6)
    ds_read_b128 a[72:75], v11 offset:2048
    ds_read_b128 a[76:79], v11 offset:3072
    v_mfma_f32_16x16x32_bf16 v[228:231], v[28:31], a[52:55], v[228:231]
    s_lshr_b32 s4, s3, 1
    ds_read_b128 a[80:83], v11 offset:4096
    s_waitcnt lgkmcnt(6)
    v_mfma_f32_16x16x32_bf16 v[232:235], v[28:31], a[56:59], v[232:235]
    s_lshl_b32 s4, s4, 10
    ds_read_b128 a[84:87], v11 offset:5120
    s_waitcnt lgkmcnt(6)
    v_mfma_f32_16x16x32_bf16 v[236:239], v[28:31], a[60:63], v[236:239]
    s_lshl3_add_u32 s4, s43, s4
    s_add_u32 s4, s4, 147456
    v_add_u32 v179, s4, v3
    v_mfma_f32_16x16x32_bf16 v[172:175], v[32:35], v[32:35], v[172:175]
    s_mov_b32 s48, 0xaaaaaaaa
    ds_read_b128 a[88:91], v11 offset:6144
    v_add_u32 v12, 147456, v3
    v_mfma_f32_16x16x32_bf16 v[172:175], v[36:39], v[36:39], v[172:175]
    s_waitcnt vmcnt(15)
    ds_read_b128 a[92:95], v11 offset:7168
    ds_read_b128 v[48:51], v186 offset:2048
    v_smfmac_f32_16x16x64_bf16 v[168:171], v[144:147], v[32:39], v191
    s_mov_b32 s49, 0xaaaaaaaa
    s_waitcnt lgkmcnt(8)
    v_lshrrev_b32 v6, 1, v1
    v_mfma_f32_16x16x32_bf16 v[224:227], v[32:35], a[64:67], v[224:227]
    s_waitcnt lgkmcnt(7)
    ds_read_b128 v[52:55], v187 offset:2048
    ds_read_b128 a[96:99], v11 offset:20480
    v_mfma_f32_16x16x32_bf16 v[228:231], v[32:35], a[68:71], v[228:231]
    s_mov_b32 s50, 0xcccccccc
    ds_read_b128 a[100:103], v11 offset:21504
    s_waitcnt lgkmcnt(9)
    v_mfma_f32_16x16x32_bf16 v[232:235], v[32:35], a[72:75], v[232:235]
    s_mov_b32 s51, 0xcccccccc
    ds_read_b128 a[104:107], v11 offset:22528
    s_waitcnt lgkmcnt(9)
    v_mfma_f32_16x16x32_bf16 v[236:239], v[32:35], a[76:79], v[236:239]
    s_mov_b32 s60, 0x00f0000f
    ds_read_b128 a[108:111], v11 offset:23552
    s_waitcnt lgkmcnt(9)
    v_mfma_f32_16x16x32_bf16 v[224:227], v[36:39], a[80:83], v[224:227]
    s_mov_b32 s61, 0xf0000f00
    ds_read_b128 a[112:115], v11 offset:24576
    s_waitcnt lgkmcnt(9)
    v_mfma_f32_16x16x32_bf16 v[228:231], v[36:39], a[84:87], v[228:231]
    s_lshl_b32 s4, s3, 3
    ds_read_b128 a[116:119], v11 offset:25600
    s_waitcnt lgkmcnt(9)
    v_mfma_f32_16x16x32_bf16 v[232:235], v[36:39], a[88:91], v[232:235]
    s_lshl_b32 s45, s43, 10
    ds_read_b128 a[120:123], v11 offset:26624
    s_waitcnt lgkmcnt(9)
    v_mfma_f32_16x16x32_bf16 v[236:239], v[36:39], a[92:95], v[236:239]
    s_waitcnt vmcnt(13)
    ds_read_b128 a[124:127], v11 offset:27648
    s_waitcnt lgkmcnt(7)
    v_mfma_f32_16x16x32_bf16 v[224:227], v[40:43], a[96:99], v[224:227]
    s_add_u32 s45, s45, 73728
    v_add_u32 v10, s45, v3
    s_waitcnt lgkmcnt(6)
    v_mfma_f32_16x16x32_bf16 v[228:231], v[40:43], a[100:103], v[228:231]
    s_waitcnt lgkmcnt(5)
    ds_read_b128 v[80:83], v10 offset:0
    v_xor_b32 v11, 1024, v10
    v_mfma_f32_16x16x32_bf16 v[232:235], v[40:43], a[104:107], v[232:235]
    s_waitcnt lgkmcnt(5)
    ds_read_b128 v[56:59], v186 offset:6144
    v_add_u32 v6, s4, v6
    v_mfma_f32_16x16x32_bf16 v[236:239], v[40:43], a[108:111], v[236:239]
    s_waitcnt lgkmcnt(5)
    ds_read_b128 v[60:63], v187 offset:6144
    v_and_b32 v7, 1, v1
    v_mfma_f32_16x16x32_bf16 v[224:227], v[44:47], a[112:115], v[224:227]
    s_waitcnt lgkmcnt(5)
    ds_read_b128 v[84:87], v11 offset:0
    v_cvt_f32_u32 v9, v7
    v_mfma_f32_16x16x32_bf16 v[228:231], v[44:47], a[116:119], v[228:231]
    s_waitcnt lgkmcnt(5)
    ds_read_b128 v[88:91], v10 offset:40960
    v_mul_f32 v9, 0xbe800000, v9
    v_mfma_f32_16x16x32_bf16 v[232:235], v[44:47], a[120:123], v[232:235]
    s_waitcnt lgkmcnt(5)
    ds_read_b128 v[92:95], v11 offset:40960
    v_lshl_add_u32 v8, v6, 1, v7
    v_mfma_f32_16x16x32_bf16 v[236:239], v[44:47], a[124:127], v[236:239]
    ds_read_b128 v[96:99], v10 offset:2048
    v_mul_f32 v224, v176, v224
    v_mfma_f32_16x16x32_bf16 v[172:175], v[40:43], v[40:43], v[172:175]
    ds_read_b128 v[100:103], v11 offset:2048
    v_mul_f32 v225, v176, v225
    v_mfma_f32_16x16x32_bf16 v[172:175], v[44:47], v[44:47], v[172:175]
    ds_read_b128 v[104:107], v10 offset:43008
    v_mul_f32 v226, v176, v226
    v_smfmac_f32_16x16x64_bf16 v[168:171], v[144:147], v[40:47], v191
    v_mul_f32 v227, v176, v227
    v_mfma_f32_16x16x32_bf16 v[172:175], v[48:51], v[48:51], v[172:175]
    v_mul_f32 v228, v176, v228
    v_mul_f32 v229, v176, v229
    v_mfma_f32_16x16x32_bf16 v[172:175], v[52:55], v[52:55], v[172:175]
    v_mul_f32 v230, v176, v230
    v_mul_f32 v231, v176, v231
    v_smfmac_f32_16x16x64_bf16 v[168:171], v[144:147], v[48:55], v191
    s_waitcnt vmcnt(11)
    s_waitcnt vmcnt(9)
    ds_read_b128 v[64:67], v186 offset:10240
    ds_read_b128 v[68:71], v187 offset:10240
    v_mul_f32 v232, v176, v232
    v_mul_f32 v233, v176, v233
    v_mul_f32 v234, v176, v234
    v_mul_f32 v235, v176, v235
    v_mfma_f32_16x16x32_bf16 v[224:227], v[48:51], a[0:3], v[224:227]
    s_waitcnt lgkmcnt(5)
    ds_read_b128 v[72:75], v186 offset:14336
    v_mul_f32 v236, v176, v236
    v_mfma_f32_16x16x32_bf16 v[228:231], v[48:51], a[4:7], v[228:231]
    ds_read_b128 v[76:79], v187 offset:14336
    v_mul_f32 v237, v176, v237
    v_mfma_f32_16x16x32_bf16 v[232:235], v[48:51], a[8:11], v[232:235]
    v_mul_f32 v238, v176, v238
    v_mul_f32 v239, v176, v239
    v_cmp_eq_u32 vcc, 1, v8
    v_lshlrev_b32 v8, 3, v2
    v_mfma_f32_16x16x32_bf16 v[236:239], v[48:51], a[12:15], v[236:239]
    ds_read_b128 v[108:111], v11 offset:43008
    v_cndmask_b32 v6, v6, 32, vcc
    v_mfma_f32_16x16x32_bf16 v[224:227], v[52:55], a[16:19], v[224:227]
    s_waitcnt lgkmcnt(3)
    ds_read_b128 v[112:115], v10 offset:20480
    v_cndmask_b32 v9, v9, 0, vcc
    v_mfma_f32_16x16x32_bf16 v[228:231], v[52:55], a[20:23], v[228:231]
    ds_read_b128 v[116:119], v11 offset:20480
    v_cvt_f32_u32 v6, v6
    v_mfma_f32_16x16x32_bf16 v[232:235], v[52:55], a[24:27], v[232:235]
    s_waitcnt lgkmcnt(3)
    ds_read_b128 v[120:123], v10 offset:61440
    v_mul_f32 v6, 0x3c800000, v6
    v_mfma_f32_16x16x32_bf16 v[236:239], v[52:55], a[28:31], v[236:239]
    ds_read_b128 v[124:127], v11 offset:61440
    v_cvt_f32_u32 v8, v8
    v_mfma_f32_16x16x32_bf16 v[172:175], v[56:59], v[56:59], v[172:175]
    ds_read_b128 v[128:131], v10 offset:22528
    v_fma_f32 v192, v6, v8, v9
    v_mfma_f32_16x16x32_bf16 v[172:175], v[60:63], v[60:63], v[172:175]
    ds_read_b128 v[132:135], v11 offset:22528
    ds_read_b128 v[136:139], v10 offset:63488
    v_smfmac_f32_16x16x64_bf16 v[168:171], v[144:147], v[56:63], v191
    ds_read_b128 v[140:143], v11 offset:63488
    v_mfma_f32_16x16x32_bf16 v[172:175], v[64:67], v[64:67], v[172:175]
    v_cos_f32 v7, v6
    v_mfma_f32_16x16x32_bf16 v[172:175], v[68:71], v[68:71], v[172:175]
    v_add_f32 v193, v192, v6
    v_cos_f32 v200, v192
    v_smfmac_f32_16x16x64_bf16 v[168:171], v[144:147], v[64:71], v191
    v_cos_f32 v201, v193
    v_mfma_f32_16x16x32_bf16 v[172:175], v[72:75], v[72:75], v[172:175]
    v_add_f32 v7, v7, v7
    v_bfe_i32 v8, v0, 1, 1
    v_mfma_f32_16x16x32_bf16 v[172:175], v[76:79], v[76:79], v[172:175]
L_pad1:
    s_cbranch_execz L_retA
    v_fma_f32 v202, v7, v201, -v200
    v_fma_f32 v203, v7, v202, -v201
    v_smfmac_f32_16x16x64_bf16 v[168:171], v[144:147], v[72:79], v191
    v_fma_f32 v204, v7, v203, -v202
    v_mfma_f32_16x16x32_bf16 v[224:227], v[56:59], a[32:35], v[224:227]
    v_fma_f32 v205, v7, v204, -v203
    v_fma_f32 v206, v7, v205, -v204
    v_mfma_f32_16x16x32_bf16 v[224:227], v[60:63], a[48:51], v[224:227]
    v_fma_f32 v207, v7, v206, -v205
    v_and_b32 v8, 0x80008000, v8
    v_mfma_f32_16x16x32_bf16 v[224:227], v[64:67], a[64:67], v[224:227]
    s_lshl_b32 s4, s3, 19
    v_cndmask_b32 v172, v172, v173, s[48:49]
    v_cndmask_b32 v174, v174, v175, s[48:49]
    v_mfma_f32_16x16x32_bf16 v[224:227], v[68:71], a[80:83], v[224:227]
    s_lshl_b32 s5, s41, 13
    v_add_f32 v168, v168, v169
    v_add_f32 v170, v170, v171
    v_mfma_f32_16x16x32_bf16 v[224:227], v[72:75], a[96:99], v[224:227]
    s_add_u32 s4, s4, s5
    v_cndmask_b32 v172, v172, v174, s[50:51]
    v_add_f32 v168, v168, v170
    v_mfma_f32_16x16x32_bf16 v[224:227], v[76:79], a[112:115], v[224:227]
    s_lshl_b32 s5, s40, 8
    v_mul_f32 v172, 0x3b000000, v172
    v_mul_f32 v168, 0x3b000000, v168
    v_mfma_f32_16x16x32_bf16 v[228:231], v[56:59], a[36:39], v[228:231]
    s_add_u32 s4, s4, s5
    v_fma_f32 v172, -v168, v168, v172
    v_max_f32 v172, 0, v172
    v_mfma_f32_16x16x32_bf16 v[228:231], v[60:63], a[52:55], v[228:231]
    s_lshr_b32 s5, s41, 1
    v_add_f32 v172, 0x3727c5ac, v172
    v_rsq_f32 v172, v172
    v_mfma_f32_16x16x32_bf16 v[228:231], v[64:67], a[68:71], v[228:231]
    v_cndmask_b32 v172, 0, v172, s[60:61]
    v_cvt_pk_bf16_f32 v160, v200, v202
    v_mfma_f32_16x16x32_bf16 v[228:231], v[68:71], a[84:87], v[228:231]
    v_cvt_pk_bf16_f32 v161, v204, v206
    v_cvt_pk_bf16_f32 v162, v201, v203
    v_mfma_f32_16x16x32_bf16 v[228:231], v[72:75], a[100:103], v[228:231]
    v_cvt_pk_bf16_f32 v163, v205, v207
    v_xor_b32 v164, v8, v160
    v_mfma_f32_16x16x4_f32 v[168:171], v172, v177, 0
    v_xor_b32 v165, v8, v161
    v_xor_b32 v166, v8, v162
    v_xor_b32 v167, v8, v163
    v_lshlrev_b32 v6, 17, v2
    v_lshl_add_u32 v6, v1, 4, v6
    v_add_u32 v178, s4, v6
    v_mfma_f32_16x16x32_bf16 v[228:231], v[76:79], a[116:119], v[228:231]
    s_lshl2_add_u32 s4, s3, s5
    s_lshl_b32 s4, s4, 13
    v_mul_f32 v224, v224, v168
    v_mfma_f32_16x16x32_bf16 v[232:235], v[56:59], a[40:43], v[232:235]
    s_and_b32 s5, s2, 6
    v_mul_f32 v225, v225, v169
    v_mul_f32 v226, v226, v170
    v_mfma_f32_16x16x32_bf16 v[232:235], v[60:63], a[56:59], v[232:235]
    s_lshl_b32 s5, s5, 3
    v_mul_f32 v227, v227, v171
    v_cvt_pk_bf16_f32 v224, v224, v225
    v_mfma_f32_16x16x32_bf16 v[232:235], v[64:67], a[72:75], v[232:235]
    s_lshr_b32 s36, s2, 5
    v_cvt_pk_bf16_f32 v225, v226, v227
    v_mul_f32 v228, v228, v168
    v_mfma_f32_16x16x32_bf16 v[232:235], v[68:71], a[88:91], v[232:235]
    s_lshl1_add_u32 s5, s36, s5
    ds_write_b64 v179, v[224:225] offset:0
    v_mfma_f32_16x16x32_bf16 v[232:235], v[72:75], a[104:107], v[232:235]
    s_and_b32 s36, s41, 1
    v_mul_f32 v229, v229, v169
    v_mul_f32 v230, v230, v170
    v_mfma_f32_16x16x32_bf16 v[232:235], v[76:79], a[120:123], v[232:235]
    s_or_b32 s5, s5, s36
    v_mul_f32 v231, v231, v171
    v_cvt_pk_bf16_f32 v228, v228, v229
    v_cvt_pk_bf16_f32 v229, v230, v231
    v_mfma_f32_16x16x32_bf16 v[236:239], v[56:59], a[44:47], v[236:239]
    s_lshr_b32 s36, s5, 4
    ds_write_b64 v179, v[228:229] offset:2048
    v_mfma_f32_16x16x32_bf16 v[236:239], v[60:63], a[60:63], v[236:239]
    s_lshl_b32 s36, s36, 7
    v_mul_f32 v232, v232, v168
    v_mul_f32 v233, v233, v169
    v_mfma_f32_16x16x32_bf16 v[236:239], v[64:67], a[76:79], v[236:239]
    s_add_u32 s4, s4, s36
    v_mul_f32 v234, v234, v170
    v_mul_f32 v235, v235, v171
    v_mfma_f32_16x16x32_bf16 v[236:239], v[68:71], a[92:95], v[236:239]
    s_and_b32 s5, s5, 15
    v_cvt_pk_bf16_f32 v232, v232, v233
    v_cvt_pk_bf16_f32 v233, v234, v235
    v_mfma_f32_16x16x32_bf16 v[236:239], v[72:75], a[108:111], v[236:239]
    s_lshl3_add_u32 s4, s5, s4
    ds_write_b64 v179, v[232:233] offset:4096
    v_mfma_f32_16x16x32_bf16 v[236:239], v[76:79], a[124:127], v[236:239]
    s_add_u32 s36, s4, 13697024
    s_mul_i32 s4, s41, 448
    s_lshr_b32 s5, s3, 1
    s_mul_i32 s5, s5, 224
    s_mul_i32 s6, s43, 96
    s_add_u32 s4, s4, s5
    s_nop 1
    v_pk_mul_f32 v[236:237], v[236:237], v[168:169]
    v_pk_mul_f32 v[238:239], v[238:239], v[170:171]
    v_cvt_pk_bf16_f32 v236, v236, v237
    v_cvt_pk_bf16_f32 v237, v238, v239
    ds_write_b64 v179, v[236:237] offset:6144
    s_add_u32 s4, s4, s6
    v_lshlrev_b32 v6, 1, v2
    v_xor_b32 v6, v6, v0
    v_and_b32 v6, 7, v6
    v_lshl_add_u32 v6, v6, 4, s4
    v_lshrrev_b32 v7, 5, v0
    v_bfe_u32 v8, v0, 3, 2
    v_lshl_add_u32 v7, v7, 3, v8
    v_sub_u32 v8, 11, v7
    s_movk_i32 s7, 3584
    v_mad_u32_u24 v148, v7, s7, v6
    v_mad_u32_u24 v155, v8, s7, v6
    v_add_u32 v149, 56320, v148
    v_add_u32 v150, 12288, v148
    v_add_u32 v151, 68608, v148
    v_add_u32 v152, 74752, v155
    v_add_u32 v153, 16384, v155
    v_add_u32 v154, 58368, v155
    s_waitcnt vmcnt(1) lgkmcnt(0)
    s_barrier
    ds_read_b128 v[32:35], v12 offset:0
    ds_read_b128 v[36:39], v12 offset:1024
    ds_read_b128 v[40:43], v12 offset:2048
    ds_read_b128 v[44:47], v12 offset:3072
    ds_read_b128 v[48:51], v12 offset:4096
    ds_read_b128 v[52:55], v12 offset:5120
    ds_read_b128 v[56:59], v12 offset:6144
    ds_read_b128 v[60:63], v12 offset:7168
    s_waitcnt lgkmcnt(6)
    v_mfma_f32_16x16x32_bf16 v[64:67], v[160:163], v[32:35], 0
    s_lshl_b32 s4, s43, 5
    v_bfe_u32 v157, v0, 3, 2
    v_and_b32 v158, 3, v0
    v_mfma_f32_16x16x32_bf16 v[64:67], v[164:167], v[36:39], v[64:67]
    s_add_u32 s6, s4, 32
    v_and_or_b32 v159, v0, 60, v157
    s_waitcnt lgkmcnt(4)
    v_mfma_f32_16x16x32_bf16 v[68:71], v[160:163], v[40:43], 0
    v_lshl_add_u32 v158, v158, 3, s1
    v_lshl_add_u32 v159, v159, 5, v158
    v_mfma_f32_16x16x32_bf16 v[68:71], v[164:167], v[44:47], v[68:71]
    v_xor_b32 v156, s4, v159
    s_waitcnt lgkmcnt(2)
    v_mfma_f32_16x16x32_bf16 v[72:75], v[160:163], v[48:51], 0
    v_xor_b32 v157, s6, v159
    v_xor_b32 v158, 64, v156
    v_mfma_f32_16x16x32_bf16 v[72:75], v[164:167], v[52:55], v[72:75]
    v_xor_b32 v159, 64, v157
    s_waitcnt lgkmcnt(0)
    v_mfma_f32_16x16x32_bf16 v[76:79], v[160:163], v[56:59], 0
    v_cvt_pk_bf16_f32 v24, v64, v65
    v_cvt_pk_bf16_f32 v28, v66, v67
    v_mfma_f32_16x16x32_bf16 v[76:79], v[164:167], v[60:63], v[76:79]
    s_mov_b32 s5, 65536
    v_cvt_pk_bf16_f32 v25, v68, v69
    v_cvt_pk_bf16_f32 v29, v70, v71
    v_cvt_pk_bf16_f32 v26, v72, v73
    v_cvt_pk_bf16_f32 v30, v74, v75
    s_nop 2
    v_cvt_pk_bf16_f32 v27, v76, v77
    v_cvt_pk_bf16_f32 v31, v78, v79
    buffer_store_dwordx4 v[24:27], v178, s[24:27], 0 offen sc1
    buffer_store_dwordx4 v[28:31], v178, s[24:27], s5 offen sc1
    s_add_u32 m0, s1, 0
    s_mul_i32 s46, s38, 229376
    buffer_load_dwordx4 v148, s[12:15], s46 offen offset:0 lds
    s_sub_u32 s4, s3, s41
    s_and_b32 s4, s4, 3
    s_lshr_b32 s5, s41, 2
    s_lshl1_add_u32 s45, s4, s5
    s_lshl_b32 s45, s45, 11
    s_add_u32 s4, s3, s41
    s_sub_u32 s4, 3, s4
    s_and_b32 s4, s4, 3
    s_xor_b32 s5, s5, 1
    s_lshl1_add_u32 s58, s4, s5
    s_lshl_b32 s58, s58, 11
    buffer_load_dwordx4 v149, s[12:15], s46 offen offset:1024 lds
    s_add_u32 s56, s1, 12288
    s_mov_b32 s59, 32768
    s_cmp_eq_u32 s40, 0
    s_cselect_b32 s6, s59, 0
    s_cselect_b32 s59, 16384, s59
    s_cmp_eq_u32 s43, 0
    s_cselect_b32 s7, 0, s6
    s_cselect_b32 s6, s6, 0
    v_xor_b32 v7, 64, v15
    v_xor_b32 v8, 0x70, v15
    v_xor_b32 v9, 0x30, v15
    v_lshrrev_b32 v10, 1, v1
    v_sub_u32 v11, 8, v2
    v_and_b32 v11, 7, v11
    v_xor_b32 v11, v11, v10
    v_lshlrev_b32 v11, 4, v11
    buffer_load_dwordx4 v150, s[12:15], s46 offen offset:2048 lds
    v_lshl_add_u32 v10, v1, 7, v11
    v_xor_b32 v11, 64, v10
    v_cmp_eq_u32 vcc, 0, v1
    v_mov_b32 v12, s6
    v_mov_b32 v13, s7
    v_cndmask_b32 v12, 0, v12, vcc
    v_cndmask_b32 v13, 0, v13, vcc
    s_add_u32 s4, s58, 4096
    s_and_b32 s4, s4, 0x3fff
    buffer_load_dwordx4 v151, s[12:15], s46 offen offset:3072 lds
    s_sub_u32 s4, s4, s58
    s_mov_b32 s5, 4294946816
    s_cmp_eq_u32 s3, 0
    s_cselect_b32 s5, 61440, s5
    s_cmp_eq_u32 s43, 0
    s_cselect_b32 s6, s4, s5
    s_cselect_b32 s7, s5, s4
    v_mov_b32 v6, v10
    s_mov_b64 exec, 0xffff
    v_add_u32 v10, s6, v10
    v_add_u32 v6, s7, v6
    s_mov_b64 exec, -1
    s_add_u32 s7, s56, 0
    s_add_u32 m0, s1, 4096
    s_mul_i32 s46, s38, 229376
    s_sub_u32 s46, 1720832, s46
    v_add_u32 v182, s46, v152
    s_cmp_eq_u32 s38, 0
    s_cselect_b64 exec, 0xff, 0
    v_subrev_u32 v182, 917504, v182
    s_mov_b64 exec, -1
    buffer_load_dwordx4 v182, s[12:15], 0 offen lds
    s_cmp_eq_u32 s43, 0
    s_cselect_b32 s4, s45, s7
    s_add_u32 s7, s56, 2048
    s_cmp_eq_u32 s43, 0
    s_cselect_b32 s5, s58, s7
    buffer_load_dwordx4 v153, s[12:15], s46 offen offset:1024 lds
    v_add_u32 v192, s4, v15
    v_add_u32 v193, s4, v7
    v_add3_u32 v194, v8, s5, v12
    v_add3_u32 v195, v9, s5, v12
    v_add3_u32 v196, v10, s5, v12
    v_add3_u32 v197, v11, s5, v12
    s_add_u32 s6, s45, s59
    buffer_load_dwordx4 v154, s[12:15], s46 offen offset:2048 lds
    ds_read_b128 v[16:19], v192
    ds_read_b128 v[20:23], v193
    ds_read_b128 v[24:27], v194
    s_add_u32 s7, s56, 4096
    s_cmp_eq_u32 s43, 0
    ds_read_b128 v[28:31], v195
    s_cselect_b32 s4, s6, s7
    s_add_u32 s6, s58, s59
    ds_read_u16 v196, v196
    ds_read_u16 v197, v197
    s_add_u32 s7, s56, 6144
    s_cmp_eq_u32 s43, 0
    s_cselect_b32 s5, s6, s7
    buffer_load_dwordx4 v155, s[12:15], s46 offen offset:3072 lds
    v_add_u32 v198, s4, v15
    v_add_u32 v199, s4, v7
    v_add_u32 v200, s5, v8
    v_add_u32 v201, s5, v9
    v_add_u32 v202, s5, v10
    v_add_u32 v203, s5, v11
    s_add_u32 m0, s1, 8192
    ds_read_b128 v[32:35], v198
    ds_read_b128 v[36:39], v199
    ds_read_b128 v[40:43], v200
    s_xor_b32 s46, s38, 1
    s_mul_i32 s46, s46, 229376
    buffer_load_dwordx4 v148, s[12:15], s46 offen offset:0 lds
    ds_read_b128 v[44:47], v201
    s_add_u32 s7, s56, 0
    ds_read_u16 v202, v202
    s_cmp_eq_u32 s43, 1
    ds_read_u16 v203, v203
    s_cselect_b32 s4, s45, s7
    s_add_u32 s7, s56, 2048
    s_cmp_eq_u32 s43, 1
    s_cselect_b32 s5, s58, s7
    buffer_load_dwordx4 v149, s[12:15], s46 offen offset:1024 lds
    v_add_u32 v204, s4, v15
    v_add_u32 v205, s4, v7
    v_add3_u32 v206, v8, s5, v13
    s_waitcnt vmcnt(10)
    s_mov_b64 exec, 1
    buffer_store_dwordx2 v[4:5], off, s[24:27], s36 sc1
    s_mov_b64 exec, -1
    v_add3_u32 v207, v9, s5, v13
    v_add3_u32 v208, v6, s5, v13
    v_add3_u32 v209, v11, s5, v13
    s_waitcnt lgkmcnt(6)
    buffer_load_dwordx4 v150, s[12:15], s46 offen offset:2048 lds
    ds_read_b128 v[48:51], v204
    ds_read_b128 v[52:55], v205
    ds_read_b128 v[56:59], v206
    buffer_load_dwordx4 v151, s[12:15], s46 offen offset:3072 lds
    ds_read_b128 v[60:63], v207
    s_add_u32 s6, s45, s59
    s_add_u32 s7, s56, 4096
    ds_read_u16 v208, v208
    s_cmp_eq_u32 s43, 1
    ds_read_u16 v209, v209
    s_cselect_b32 s4, s6, s7
    s_add_u32 s6, s58, s59
    s_add_u32 s7, s56, 6144
    s_cmp_eq_u32 s43, 1
    s_cselect_b32 s5, s6, s7
    v_add_u32 v210, s4, v15
    v_add_u32 v211, s4, v7
    v_add_u32 v212, s5, v8
    v_add_u32 v213, s5, v9
    v_add_u32 v214, s5, v6
    v_add_u32 v215, s5, v11
    s_waitcnt lgkmcnt(6)
    ds_read_b128 v[64:67], v210
    ds_read_b128 v[68:71], v211
    ds_read_b128 v[72:75], v212
    v_mov_b32 v6, 0xbf80
    v_mov_b32 v7, -1.0
    v_cndmask_b32 v6, v6, v7, s[48:49]
    v_cndmask_b32 v6, 0, v6, s[60:61]
    v_cndmask_b32 v178, v6, 0, s[50:51]
    ds_read_b128 v[76:79], v213
    ds_read_u16 v214, v214
    ds_read_u16 v215, v215
    v_cndmask_b32 v179, 0, v6, s[50:51]
    v_mov_b32 v176, 0
    v_mov_b32 v177, 0
    v_mov_b32 v180, 0
    v_mov_b32 v181, 0
    v_and_b32 v6, 0xffff, v178
    v_and_b32 v8, 0xffff0000, v179
    v_xor_b32 v9, v178, v179
    v_xor_b32 v9, v9, v6
    v_xor_b32 v9, v9, v8
    v_mov_b32 v7, 0
    v_mov_b32 v10, v8
    v_mov_b32 v11, v9
    v_mov_b32 v12, v6
    v_mov_b32 v13, 0
    v_cmp_eq_u32 vcc, 0, v2
    s_cmp_eq_u32 s3, 0
    s_cselect_b64 s[56:57], vcc, 0
    s_waitcnt lgkmcnt(0)
    s_barrier
    s_add_u32 m0, s1, 12288
    s_xor_b32 s46, s38, 1
    s_mul_i32 s46, s46, 229376
    s_sub_u32 s46, 1720832, s46
    v_add_u32 v182, s46, v152
    s_cmp_eq_u32 s38, 1
    s_cselect_b64 exec, 0xff, 0
    v_subrev_u32 v182, 917504, v182
    s_mov_b64 exec, -1
    buffer_load_dwordx4 v182, s[12:15], 0 offen lds
    buffer_load_dwordx4 v153, s[12:15], s46 offen offset:1024 lds
    s_waitcnt vmcnt(11)
    ds_read_b64_tr_b16 a[0:1], v156 offset:0
    ds_read_b64_tr_b16 a[2:3], v156 offset:2048
    ds_read_b64_tr_b16 a[4:5], v157 offset:0
    ds_read_b64_tr_b16 a[6:7], v157 offset:2048
    ds_read_b64_tr_b16 a[8:9], v158 offset:0
    ds_read_b64_tr_b16 a[10:11], v158 offset:2048
    ds_read_b64_tr_b16 a[12:13], v159 offset:0
    buffer_load_dwordx4 v154, s[12:15], s46 offen offset:2048 lds
    ds_read_b64_tr_b16 a[14:15], v159 offset:2048
    s_mov_b32 s4, 0xffff
    v_bfi_b32 v24, s4, v196, v24
    v_bfi_b32 v28, s4, v197, v28
    v_bfi_b32 v40, s4, v202, v40
    v_bfi_b32 v44, s4, v203, v44
    v_mfma_f32_16x16x32_bf16 v[200:203], v[178:181], v[32:35], 0
    buffer_load_dwordx4 v155, s[12:15], s46 offen offset:3072 lds
    v_mfma_f32_16x16x32_bf16 v[204:207], v[176:179], v[32:35], 0
    s_add_u32 m0, s1, 16384
    v_bfi_b32 v56, s4, v208, v56
    v_bfi_b32 v60, s4, v209, v60
    v_mfma_f32_16x16x32_bf16 v[232:235], v[6:9], v[40:43], 0
    s_xor_b32 s46, s38, 2
    v_bfi_b32 v72, s4, v214, v72
    v_bfi_b32 v76, s4, v215, v76
    v_mfma_f32_16x16x32_bf16 v[236:239], v[10:13], v[40:43], 0
    s_mul_i32 s46, s46, 229376
    v_mfma_f32_16x16x32_bf16 v[192:195], v[178:181], v[16:19], 0
    buffer_load_dwordx4 v148, s[12:15], s46 offen offset:0 lds
    v_mfma_f32_16x16x32_bf16 v[196:199], v[176:179], v[16:19], 0
    v_mfma_f32_16x16x32_bf16 v[224:227], v[6:9], v[24:27], 0
    v_mfma_f32_16x16x32_bf16 v[228:231], v[10:13], v[24:27], 0
    buffer_load_dwordx4 v149, s[12:15], s46 offen offset:1024 lds
    v_mfma_f32_16x16x32_bf16 v[216:219], v[178:181], v[36:39], 0
    s_waitcnt vmcnt(11)
    ds_read_b64_tr_b16 a[16:17], v156 offset:4096
    ds_read_b64_tr_b16 a[18:19], v156 offset:6144
    v_mfma_f32_16x16x32_bf16 v[220:223], v[176:179], v[36:39], 0
    buffer_load_dwordx4 v150, s[12:15], s46 offen offset:2048 lds
    v_mfma_f32_16x16x32_bf16 v[248:251], v[6:9], v[44:47], 0
    ds_read_b64_tr_b16 a[20:21], v157 offset:4096
    ds_read_b64_tr_b16 a[22:23], v157 offset:6144
    v_mfma_f32_16x16x32_bf16 v[252:255], v[10:13], v[44:47], 0
    ds_read_b64_tr_b16 a[24:25], v158 offset:4096
    ds_read_b64_tr_b16 a[26:27], v158 offset:6144
    v_mfma_f32_16x16x32_bf16 v[208:211], v[178:181], v[20:23], 0
    ds_read_b64_tr_b16 a[28:29], v159 offset:4096
    ds_read_b64_tr_b16 a[30:31], v159 offset:6144
    v_mfma_f32_16x16x32_bf16 v[212:215], v[176:179], v[20:23], 0
    buffer_load_dwordx4 v151, s[12:15], s46 offen offset:3072 lds
    v_mfma_f32_16x16x32_bf16 v[240:243], v[6:9], v[28:31], 0
    s_add_u32 m0, s1, 0
    v_lshlrev_b32 v184, 16, v16
    v_lshlrev_b32 v185, 16, v32
    v_mfma_f32_16x16x32_bf16 v[244:247], v[10:13], v[28:31], 0
    s_waitcnt lgkmcnt(8)
    v_lshlrev_b32 v186, 16, v48
    v_lshlrev_b32 v187, 16, v64
    v_and_b32 v178, 0x7fff7fff, v178
    v_and_b32 v179, 0x7fff7fff, v179
    v_and_b32 v6, 0x7fff7fff, v6
    v_and_b32 v8, 0x7fff7fff, v8
    s_xor_b32 s46, s38, 2
    s_mul_i32 s46, s46, 229376
    s_sub_u32 s46, 1720832, s46
    v_add_u32 v182, s46, v152
    s_cmp_eq_u32 s38, 2
    s_cselect_b64 exec, 0xff, 0
    v_subrev_u32 v182, 917504, v182
    s_mov_b64 exec, -1
    buffer_load_dwordx4 v182, s[12:15], 0 offen lds
    v_and_b32 v9, 0x7fff7fff, v9
    s_waitcnt vmcnt(9)
    buffer_load_dwordx4 v153, s[12:15], s46 offen offset:1024 lds
    v_mfma_f32_16x16x32_bf16 v[200:203], v[6:9], v[72:75], v[200:203]
    buffer_load_dwordx4 v154, s[12:15], s46 offen offset:2048 lds
    ds_read_b64_tr_b16 a[32:33], v156 offset:8192
    ds_read_b64_tr_b16 a[34:35], v156 offset:10240
    ds_read_b64_tr_b16 a[36:37], v157 offset:8192
    ds_read_b64_tr_b16 a[38:39], v157 offset:10240
    ds_read_b64_tr_b16 a[40:41], v158 offset:8192
    ds_read_b64_tr_b16 a[42:43], v158 offset:10240
    ds_read_b64_tr_b16 a[44:45], v159 offset:8192
    v_and_b32 v10, 0x7fff7fff, v10
    v_and_b32 v11, 0x7fff7fff, v11
    v_and_b32 v12, 0x7fff7fff, v12
    ds_read_b64_tr_b16 a[46:47], v159 offset:10240
    s_nop 0
    v_mfma_f32_16x16x32_bf16 v[204:207], v[10:13], v[72:75], v[204:207]
    v_mfma_f32_16x16x32_bf16 v[232:235], v[178:181], v[64:67], v[232:235]
    v_cvt_pk_bf16_f32 v72, v200, v201
    v_mfma_f32_16x16x32_bf16 v[236:239], v[176:179], v[64:67], v[236:239]
    v_mfma_f32_16x16x32_bf16 v[192:195], v[6:9], v[56:59], v[192:195]
    buffer_load_dwordx4 v155, s[12:15], s46 offen offset:3072 lds
    v_mfma_f32_16x16x32_bf16 v[196:199], v[10:13], v[56:59], v[196:199]
    s_add_u32 m0, s1, 4096
    s_xor_b32 s46, s38, 3
    s_mul_i32 s46, s46, 229376
    v_mfma_f32_16x16x32_bf16 v[224:227], v[178:181], v[48:51], v[224:227]
    v_cvt_pk_bf16_f32 v73, v202, v203
    v_cvt_pk_bf16_f32 v74, v204, v205
    v_mfma_f32_16x16x32_bf16 v[228:231], v[176:179], v[48:51], v[228:231]
    v_cvt_pk_bf16_f32 v75, v206, v207
    v_mfma_f32_16x16x32_bf16 v[216:219], v[6:9], v[76:79], v[216:219]
    v_accvgpr_write_b32 a224, v72
    v_mfma_f32_16x16x32_bf16 v[220:223], v[10:13], v[76:79], v[220:223]
    s_waitcnt lgkmcnt(8)
    v_mfma_f32_16x16x32_bf16 v[248:251], v[178:181], v[68:71], v[248:251]
    buffer_load_dwordx4 v148, s[12:15], s46 offen offset:0 lds
    v_mfma_f32_16x16x32_bf16 v[252:255], v[176:179], v[68:71], v[252:255]
    buffer_load_dwordx4 v149, s[12:15], s46 offen offset:1024 lds
    v_mfma_f32_16x16x32_bf16 v[208:211], v[6:9], v[60:63], v[208:211]
    v_mfma_f32_16x16x32_bf16 v[212:215], v[10:13], v[60:63], v[212:215]
    v_accvgpr_write_b32 a225, v73
    v_mfma_f32_16x16x32_bf16 v[240:243], v[178:181], v[52:55], v[240:243]
    buffer_load_dwordx4 v150, s[12:15], s46 offen offset:2048 lds
    v_mfma_f32_16x16x32_bf16 v[244:247], v[176:179], v[52:55], v[244:247]
    v_accvgpr_write_b32 a226, v74
    v_accvgpr_write_b32 a227, v75
    v_mfma_f32_16x16x32_bf16 v[200:203], v[178:181], v[32:35], 0
    v_cvt_pk_bf16_f32 v64, v232, v233
    v_mfma_f32_16x16x32_bf16 v[204:207], v[176:179], v[32:35], 0
    s_waitcnt vmcnt(11)
    ds_read_b64_tr_b16 a[48:49], v156 offset:12288
    ds_read_b64_tr_b16 a[50:51], v156 offset:14336
    buffer_load_dwordx4 v151, s[12:15], s46 offen offset:3072 lds
    ds_read_b64_tr_b16 a[52:53], v157 offset:12288
    ds_read_b64_tr_b16 a[54:55], v157 offset:14336
    ds_read_b64_tr_b16 a[56:57], v158 offset:12288
    ds_read_b64_tr_b16 a[58:59], v158 offset:14336
    ds_read_b64_tr_b16 a[60:61], v159 offset:12288
    ds_read_b64_tr_b16 a[62:63], v159 offset:14336
    s_waitcnt lgkmcnt(8)
    s_add_u32 m0, s1, 8192
    s_xor_b32 s46, s38, 3
    s_mul_i32 s46, s46, 229376
    s_sub_u32 s46, 1720832, s46
    v_add_u32 v182, s46, v152
    s_cmp_eq_u32 s38, 3
    s_cselect_b64 exec, 0xff, 0
    v_subrev_u32 v182, 917504, v182
    s_mov_b64 exec, -1
    buffer_load_dwordx4 v182, s[12:15], 0 offen lds
    v_cvt_pk_bf16_f32 v65, v234, v235
    v_mfma_f32_16x16x32_bf16 v[232:235], v[6:9], v[40:43], 0
    buffer_load_dwordx4 v153, s[12:15], s46 offen offset:1024 lds
    v_cvt_pk_bf16_f32 v66, v236, v237
    v_cvt_pk_bf16_f32 v67, v238, v239
    v_mfma_f32_16x16x32_bf16 v[236:239], v[10:13], v[40:43], 0
    buffer_load_dwordx4 v154, s[12:15], s46 offen offset:2048 lds
    v_accvgpr_write_b32 a228, v64
    v_accvgpr_write_b32 a229, v65
    v_accvgpr_write_b32 a230, v66
    v_accvgpr_write_b32 a231, v67
    v_cvt_pk_bf16_f32 v56, v192, v193
    v_cvt_pk_bf16_f32 v57, v194, v195
    v_mfma_f32_16x16x32_bf16 v[192:195], v[178:181], v[16:19], 0
    v_cvt_pk_bf16_f32 v58, v196, v197
    v_cvt_pk_bf16_f32 v59, v198, v199
    v_mfma_f32_16x16x32_bf16 v[196:199], v[176:179], v[16:19], 0
    s_waitcnt vmcnt(11)
    ds_read_b64_tr_b16 a[64:65], v156 offset:16384
    ds_read_b64_tr_b16 a[66:67], v156 offset:18432
    v_accvgpr_write_b32 a232, v56
    v_accvgpr_write_b32 a233, v57
    v_accvgpr_write_b32 a234, v58
    buffer_load_dwordx4 v155, s[12:15], s46 offen offset:3072 lds
    ds_read_b64_tr_b16 a[68:69], v157 offset:16384
    ds_read_b64_tr_b16 a[70:71], v157 offset:18432
    ds_read_b64_tr_b16 a[72:73], v158 offset:16384
    ds_read_b64_tr_b16 a[74:75], v158 offset:18432
    ds_read_b64_tr_b16 a[76:77], v159 offset:16384
    ds_read_b64_tr_b16 a[78:79], v159 offset:18432
    v_accvgpr_write_b32 a235, v59
    v_cvt_pk_bf16_f32 v48, v224, v225
    v_cvt_pk_bf16_f32 v49, v226, v227
    v_mfma_f32_16x16x32_bf16 v[224:227], v[6:9], v[24:27], 0
    s_waitcnt lgkmcnt(8)
    v_cvt_pk_bf16_f32 v50, v228, v229
    v_cvt_pk_bf16_f32 v51, v230, v231
    v_mfma_f32_16x16x32_bf16 v[228:231], v[10:13], v[24:27], 0
    s_add_u32 m0, s1, 12288
    s_mul_i32 s46, s38, 229376
    v_accvgpr_write_b32 a236, v48
    s_add_u32 s46, s46, 114688
    buffer_load_dwordx4 v148, s[12:15], s46 offen offset:0 lds
    v_accvgpr_write_b32 a237, v49
    v_accvgpr_write_b32 a238, v50
    v_accvgpr_write_b32 a239, v51
    v_cvt_pk_bf16_f32 v76, v216, v217
    buffer_load_dwordx4 v149, s[12:15], s46 offen offset:1024 lds
    v_cvt_pk_bf16_f32 v77, v218, v219
    v_mfma_f32_16x16x32_bf16 v[216:219], v[178:181], v[36:39], 0
    buffer_load_dwordx4 v150, s[12:15], s46 offen offset:2048 lds
    v_cvt_pk_bf16_f32 v78, v220, v221
    v_cvt_pk_bf16_f32 v79, v222, v223
    v_mfma_f32_16x16x32_bf16 v[220:223], v[176:179], v[36:39], 0
    v_accvgpr_write_b32 a240, v76
    v_accvgpr_write_b32 a241, v77
    v_accvgpr_write_b32 a242, v78
    v_accvgpr_write_b32 a243, v79
    v_cvt_pk_bf16_f32 v68, v248, v249
    v_cvt_pk_bf16_f32 v69, v250, v251
    v_mfma_f32_16x16x32_bf16 v[248:251], v[6:9], v[44:47], 0
    buffer_load_dwordx4 v151, s[12:15], s46 offen offset:3072 lds
    v_cvt_pk_bf16_f32 v70, v252, v253
    v_cvt_pk_bf16_f32 v71, v254, v255
    v_mfma_f32_16x16x32_bf16 v[252:255], v[10:13], v[44:47], 0
    s_waitcnt vmcnt(12)
    ds_read_b64_tr_b16 a[80:81], v156 offset:0
    ds_read_b64_tr_b16 a[82:83], v156 offset:2048
    ds_read_b64_tr_b16 a[84:85], v157 offset:0
    ds_read_b64_tr_b16 a[86:87], v157 offset:2048
    ds_read_b64_tr_b16 a[88:89], v158 offset:0
    ds_read_b64_tr_b16 a[90:91], v158 offset:2048
    ds_read_b64_tr_b16 a[92:93], v159 offset:0
    v_accvgpr_write_b32 a244, v68
    v_accvgpr_write_b32 a245, v69
    s_waitcnt lgkmcnt(7)
    s_add_u32 m0, s1, 16384
    ds_read_b64_tr_b16 a[94:95], v159 offset:2048
    s_mul_i32 s46, s38, 229376
    s_sub_u32 s46, 1606144, s46
    buffer_load_dwordx4 v152, s[12:15], s46 offen offset:0 lds
    v_accvgpr_write_b32 a246, v70
    v_accvgpr_write_b32 a247, v71
    v_cvt_pk_bf16_f32 v60, v208, v209
    v_cvt_pk_bf16_f32 v61, v210, v211
    v_mfma_f32_16x16x32_bf16 v[208:211], v[178:181], v[20:23], 0
    buffer_load_dwordx4 v153, s[12:15], s46 offen offset:1024 lds
    v_cvt_pk_bf16_f32 v62, v212, v213
    v_cvt_pk_bf16_f32 v63, v214, v215
    v_mfma_f32_16x16x32_bf16 v[212:215], v[176:179], v[20:23], 0
    s_lshr_b32 s4, s40, 3
    v_accvgpr_write_b32 a248, v60
    v_accvgpr_write_b32 a249, v61
    v_accvgpr_write_b32 a250, v62
    v_accvgpr_write_b32 a251, v63
    v_cvt_pk_bf16_f32 v52, v240, v241
    v_cvt_pk_bf16_f32 v53, v242, v243
    v_mfma_f32_16x16x32_bf16 v[240:243], v[6:9], v[28:31], 0
    buffer_load_dwordx4 v154, s[12:15], s46 offen offset:2048 lds
    v_cvt_pk_bf16_f32 v54, v244, v245
    v_cvt_pk_bf16_f32 v55, v246, v247
    v_mfma_f32_16x16x32_bf16 v[244:247], v[10:13], v[28:31], 0
    s_waitcnt vmcnt(11)
    ds_read_b64_tr_b16 a[96:97], v156 offset:4096
    ds_read_b64_tr_b16 a[98:99], v156 offset:6144
    v_accvgpr_write_b32 a252, v52
    v_accvgpr_write_b32 a253, v53
L_pad2:
    s_cbranch_execz L_retA
    v_accvgpr_write_b32 a254, v54
    v_accvgpr_write_b32 a255, v55
    s_lshl2_add_u32 s4, s4, s3
    s_lshl_b32 s4, s4, 13
    s_add_u32 s4, s4, 13697024
    v_lshl_add_u32 v15, v0, 3, s4
    s_lshl2_add_u32 s4, s40, s3
    buffer_load_dwordx4 v155, s[12:15], s46 offen offset:3072 lds
    ds_read_b64_tr_b16 a[100:101], v157 offset:4096
    ds_read_b64_tr_b16 a[102:103], v157 offset:6144
    ds_read_b64_tr_b16 a[104:105], v158 offset:4096
    ds_read_b64_tr_b16 a[106:107], v158 offset:6144
    ds_read_b64_tr_b16 a[108:109], v159 offset:4096
    ds_read_b64_tr_b16 a[110:111], v159 offset:6144
    s_lshl_b32 s4, s4, 14
    s_and_b32 s7, s41, 0
    s_lshl_b32 s7, s7, 19
    s_add_u32 s4, s4, s7
    v_add_u32 v188, s4, v3
    v_add_u32 v189, 8192, v188
    s_and_b32 s7, s41, 3
    s_lshl_b32 s7, s7, 11
    s_lshl1_add_u32 s58, s7, s4
    s_lshl_b32 s5, s43, 11
    s_add_u32 s5, s5, s0
    v_add_u32 v10, s5, v3
    v_xor_b32 v11, 2048, v10
    s_xor_b32 s5, s3, s38
    s_lshl_b32 s5, s5, 14
    v_xor_b32 v8, s5, v10
    v_xor_b32 v9, s5, v11
    s_lshl3_add_u32 s52, s40, s41
    s_lshl2_add_u32 s52, s52, s3
    s_lshl_b32 s52, s52, 14
    s_add_u32 s52, s52, 16777216
    s_andn2_b32 s101, s52, 212992
    s_add_u32 s101, s101, 7168
    v_readfirstlane_b32 s100, v4
    v_and_b32 v6, 7, v0
    s_and_b32 s100, s100, 0xbfffbfff
    s_lshl_b32 s4, s40, 10
    s_add_u32 s4, s4, 13664256
    v_lshlrev_b32 v6, 7, v6
    s_waitcnt lgkmcnt(8)
    buffer_load_dwordx2 v[12:13], v15, s[24:27], 0 offen sc1
    buffer_load_dwordx2 v[6:7], v6, s[24:27], s4 offen sc1
    s_add_u32 m0, s1, 0
    s_xor_b32 s46, s38, 1
    s_mul_i32 s46, s46, 229376
    s_add_u32 s46, s46, 114688
    buffer_load_dwordx4 v148, s[12:15], s46 offen offset:0 lds
    buffer_load_dwordx4 v149, s[12:15], s46 offen offset:1024 lds
    v_mov_b64 v[160:161], 0
    v_mov_b64 v[162:163], 0
    s_nop 1
    v_smfmac_f32_16x16x64_bf16 v[160:163], v[144:147], a[0:7], v191
    s_waitcnt vmcnt(12)
    ds_read_b64_tr_b16 a[112:113], v156 offset:8192
    buffer_load_dwordx4 v150, s[12:15], s46 offen offset:2048 lds
    ds_read_b64_tr_b16 a[114:115], v156 offset:10240
    ds_read_b64_tr_b16 a[116:117], v157 offset:8192
    ds_read_b64_tr_b16 a[118:119], v157 offset:10240
    ds_read_b64_tr_b16 a[120:121], v158 offset:8192
    ds_read_b64_tr_b16 a[122:123], v158 offset:10240
    ds_read_b64_tr_b16 a[124:125], v159 offset:8192
    ds_read_b64_tr_b16 a[126:127], v159 offset:10240
    v_mov_b64 v[168:169], 0
    v_mov_b64 v[170:171], 0
    buffer_load_dwordx4 v151, s[12:15], s46 offen offset:3072 lds
    s_nop 0
    v_smfmac_f32_16x16x64_bf16 v[168:171], v[144:147], a[8:15], v191
    s_add_u32 m0, s1, 4096
    s_xor_b32 s46, s38, 1
    s_mul_i32 s46, s46, 229376
    v_smfmac_f32_16x16x64_bf16 v[160:163], v[144:147], a[16:23], v191
    s_sub_u32 s46, 1606144, s46
    v_smfmac_f32_16x16x64_bf16 v[168:171], v[144:147], a[24:31], v191
    v_smfmac_f32_16x16x64_bf16 v[160:163], v[144:147], a[32:39], v191
    v_smfmac_f32_16x16x64_bf16 v[168:171], v[144:147], a[40:47], v191
    s_waitcnt lgkmcnt(8)
    v_smfmac_f32_16x16x64_bf16 v[160:163], v[144:147], a[48:55], v191
    buffer_load_dwordx4 v152, s[12:15], s46 offen offset:0 lds
    v_smfmac_f32_16x16x64_bf16 v[168:171], v[144:147], a[56:63], v191
    buffer_load_dwordx4 v153, s[12:15], s46 offen offset:1024 lds
    v_smfmac_f32_16x16x64_bf16 v[160:163], v[144:147], a[64:71], v191
    v_smfmac_f32_16x16x64_bf16 v[168:171], v[144:147], a[72:79], v191
    v_smfmac_f32_16x16x64_bf16 v[160:163], v[144:147], a[80:87], v191
    v_smfmac_f32_16x16x64_bf16 v[168:171], v[144:147], a[88:95], v191
    s_waitcnt vmcnt(12)
    ds_read_b64_tr_b16 a[128:129], v156 offset:12288
    v_smfmac_f32_16x16x64_bf16 v[160:163], v[144:147], a[96:103], v191
    buffer_load_dwordx4 v154, s[12:15], s46 offen offset:2048 lds
    v_smfmac_f32_16x16x64_bf16 v[168:171], v[144:147], a[104:111], v191
    ds_read_b64_tr_b16 a[130:131], v156 offset:14336
    ds_read_b64_tr_b16 a[132:133], v157 offset:12288
    ds_read_b64_tr_b16 a[134:135], v157 offset:14336
    ds_read_b64_tr_b16 a[136:137], v158 offset:12288
    ds_read_b64_tr_b16 a[138:139], v158 offset:14336
    ds_read_b64_tr_b16 a[140:141], v159 offset:12288
    ds_read_b64_tr_b16 a[142:143], v159 offset:14336
    buffer_load_dwordx4 v155, s[12:15], s46 offen offset:3072 lds
    s_waitcnt vmcnt(9)
    v_cmp_ne_u64 vcc, v[12:13], v[4:5]
    s_mov_b32 s36, 0x20000
    s_cbranch_vccz L_polld_3
L_poll_2:
    buffer_load_dwordx2 v[12:13], v15, s[24:27], 0 offen sc1
    s_sub_u32 s36, s36, 1
    s_cbranch_scc1 L_polld_3
    s_waitcnt vmcnt(0)
    v_cmp_ne_u64 vcc, v[12:13], v[4:5]
    s_cbranch_vccnz L_poll_2
L_polld_3:
    buffer_load_dwordx4 v[16:19], v188, s[24:27], s7 offen offset:0 sc1
    buffer_load_dwordx4 v[20:23], v188, s[24:27], s7 offen offset:1024 sc1
    s_add_u32 s7, s7, 2048
    s_and_b32 s7, s7, 0x1800
    buffer_load_dwordx4 v[24:27], v188, s[24:27], s7 offen offset:0 sc1
    buffer_load_dwordx4 v[28:31], v188, s[24:27], s7 offen offset:1024 sc1
    s_add_u32 s7, s7, 2048
    s_and_b32 s7, s7, 0x1800
    buffer_load_dwordx4 v[32:35], v188, s[24:27], s7 offen offset:0 sc1
    buffer_load_dwordx4 v[36:39], v188, s[24:27], s7 offen offset:1024 sc1
    s_mov_b64 exec, 0
    s_cmp_eq_u32 s3, 0
    s_cbranch_scc1 L_pad3
    s_cmp_eq_u32 s3, 1
    s_cbranch_scc1 L_pad4
    s_cmp_eq_u32 s3, 2
    s_cbranch_scc1 L_pad5
L_retB:
    s_mov_b64 exec, -1
    s_getreg_b32 s37, hwreg(HW_REG_XCC_ID)
    s_and_b32 s37, s37, 15
    s_waitcnt lgkmcnt(8)
    v_smfmac_f32_16x16x64_bf16 v[160:163], v[144:147], a[112:119], v191
    v_smfmac_f32_16x16x64_bf16 v[168:171], v[144:147], a[120:127], v191
    s_waitcnt lgkmcnt(0)
    v_smfmac_f32_16x16x64_bf16 v[160:163], v[144:147], a[128:135], v191
    v_smfmac_f32_16x16x64_bf16 v[168:171], v[144:147], a[136:143], v191
    ds_read_b64_tr_b16 a[144:145], v156 offset:16384
    ds_read_b64_tr_b16 a[146:147], v156 offset:18432
    ds_read_b64_tr_b16 a[148:149], v157 offset:16384
    ds_read_b64_tr_b16 a[150:151], v157 offset:18432
    s_add_u32 s7, s7, 2048
    s_and_b32 s7, s7, 0x1800
    buffer_load_dwordx4 v[40:43], v188, s[24:27], s7 offen offset:0 sc1
    buffer_load_dwordx4 v[44:47], v188, s[24:27], s7 offen offset:1024 sc1
    ds_read_b64_tr_b16 a[152:153], v158 offset:16384
    ds_read_b64_tr_b16 a[154:155], v158 offset:18432
    ds_read_b64_tr_b16 a[156:157], v159 offset:16384
    ds_read_b64_tr_b16 a[158:159], v159 offset:18432
    s_waitcnt vmcnt(12)
    ds_read_b64_tr_b16 a[160:161], v156 offset:0
    ds_read_b64_tr_b16 a[162:163], v156 offset:2048
    ds_read_b64_tr_b16 a[164:165], v157 offset:0
    ds_read_b64_tr_b16 a[166:167], v157 offset:2048
    s_add_u32 s7, s7, 2048
    s_and_b32 s7, s7, 0x1800
    buffer_load_dwordx4 v[48:51], v189, s[24:27], s7 offen offset:0 sc1
    buffer_load_dwordx4 v[52:55], v189, s[24:27], s7 offen offset:1024 sc1
    ds_read_b64_tr_b16 a[168:169], v158 offset:0
    ds_read_b64_tr_b16 a[170:171], v158 offset:2048
    ds_read_b64_tr_b16 a[172:173], v159 offset:0
    ds_read_b64_tr_b16 a[174:175], v159 offset:2048
    s_waitcnt vmcnt(10)
    ds_read_b64_tr_b16 a[176:177], v156 offset:4096
    ds_read_b64_tr_b16 a[178:179], v156 offset:6144
    ds_read_b64_tr_b16 a[180:181], v157 offset:4096
    ds_read_b64_tr_b16 a[182:183], v157 offset:6144
    s_add_u32 s7, s7, 2048
    s_and_b32 s7, s7, 0x1800
    buffer_load_dwordx4 v[56:59], v189, s[24:27], s7 offen offset:0 sc1
    buffer_load_dwordx4 v[60:63], v189, s[24:27], s7 offen offset:1024 sc1
    ds_read_b64_tr_b16 a[184:185], v158 offset:4096
    ds_read_b64_tr_b16 a[186:187], v158 offset:6144
    ds_read_b64_tr_b16 a[188:189], v159 offset:4096
    ds_read_b64_tr_b16 a[190:191], v159 offset:6144
    s_waitcnt lgkmcnt(15)
    v_smfmac_f32_16x16x64_bf16 v[160:163], v[144:147], a[144:151], v191
    v_smfmac_f32_16x16x64_bf16 v[168:171], v[144:147], a[152:159], v191
    s_waitcnt lgkmcnt(8)
    v_smfmac_f32_16x16x64_bf16 v[160:163], v[144:147], a[160:167], v191
    v_smfmac_f32_16x16x64_bf16 v[168:171], v[144:147], a[168:175], v191
    s_waitcnt lgkmcnt(0)
    v_smfmac_f32_16x16x64_bf16 v[160:163], v[144:147], a[176:183], v191
    v_smfmac_f32_16x16x64_bf16 v[168:171], v[144:147], a[184:191], v191
    s_waitcnt vmcnt(10)
    s_add_u32 s7, s7, 2048
    v_swap_b32 v18, v20
    v_swap_b32 v19, v21
    s_nop 1
    v_mfma_f32_16x16x32_bf16 v[200:203], v[16:19], v[88:91], v[200:203]
    s_and_b32 s7, s7, 0x1800
    v_mfma_f32_16x16x32_bf16 v[204:207], v[20:23], v[88:91], v[204:207]
    buffer_load_dwordx4 v[64:67], v189, s[24:27], s7 offen offset:0 sc1
    v_mfma_f32_16x16x32_bf16 v[232:235], v[16:19], v[92:95], v[232:235]
    buffer_load_dwordx4 v[68:71], v189, s[24:27], s7 offen offset:1024 sc1
    v_mfma_f32_16x16x32_bf16 v[236:239], v[20:23], v[92:95], v[236:239]
    s_add_u32 s7, s7, 2048
    s_and_b32 s7, s7, 0x1800
    v_mfma_f32_16x16x32_bf16 v[192:195], v[16:19], v[80:83], v[192:195]
    v_mfma_f32_16x16x32_bf16 v[196:199], v[20:23], v[80:83], v[196:199]
    v_mfma_f32_16x16x32_bf16 v[224:227], v[16:19], v[84:87], v[224:227]
    v_mfma_f32_16x16x32_bf16 v[228:231], v[20:23], v[84:87], v[228:231]
    s_waitcnt vmcnt(10)
    v_swap_b32 v26, v28
    v_swap_b32 v27, v29
    s_add_u32 m0, s1, 8192
    s_nop 0
    v_mfma_f32_16x16x32_bf16 v[200:203], v[24:27], v[104:107], v[200:203]
    buffer_load_dwordx4 v[72:75], v189, s[24:27], s7 offen offset:0 sc1
    v_mfma_f32_16x16x32_bf16 v[204:207], v[28:31], v[104:107], v[204:207]
    buffer_load_dwordx4 v[76:79], v189, s[24:27], s7 offen offset:1024 sc1
    v_mfma_f32_16x16x32_bf16 v[232:235], v[24:27], v[108:111], v[232:235]
    s_xor_b32 s46, s38, 2
    s_mul_i32 s46, s46, 229376
    s_add_u32 s46, s46, 114688
    v_mfma_f32_16x16x32_bf16 v[236:239], v[28:31], v[108:111], v[236:239]
    v_mfma_f32_16x16x32_bf16 v[192:195], v[24:27], v[96:99], v[192:195]
    v_mfma_f32_16x16x32_bf16 v[196:199], v[28:31], v[96:99], v[196:199]
    v_mfma_f32_16x16x32_bf16 v[224:227], v[24:27], v[100:103], v[224:227]
    v_mfma_f32_16x16x32_bf16 v[228:231], v[28:31], v[100:103], v[228:231]
    s_waitcnt vmcnt(10)
    v_swap_b32 v34, v36
    v_swap_b32 v35, v37
    s_nop 1
    v_mfma_f32_16x16x32_bf16 v[200:203], v[32:35], v[120:123], v[200:203]
    v_mfma_f32_16x16x32_bf16 v[204:207], v[36:39], v[120:123], v[204:207]
    v_mfma_f32_16x16x32_bf16 v[232:235], v[32:35], v[124:127], v[232:235]
    v_mfma_f32_16x16x32_bf16 v[236:239], v[36:39], v[124:127], v[236:239]
    v_mfma_f32_16x16x32_bf16 v[192:195], v[32:35], v[112:115], v[192:195]
    v_mfma_f32_16x16x32_bf16 v[196:199], v[36:39], v[112:115], v[196:199]
    s_cmp_lg_u32 s40, 0
    v_mfma_f32_16x16x32_bf16 v[224:227], v[32:35], v[116:119], v[224:227]
    v_mfma_f32_16x16x32_bf16 v[228:231], v[36:39], v[116:119], v[228:231]
    s_waitcnt vmcnt(8)
    v_swap_b32 v42, v44
    v_swap_b32 v43, v45
    s_nop 1
    v_mfma_f32_16x16x32_bf16 v[200:203], v[40:43], v[136:139], v[200:203]
    v_mfma_f32_16x16x32_bf16 v[204:207], v[44:47], v[136:139], v[204:207]
    v_mfma_f32_16x16x32_bf16 v[232:235], v[40:43], v[140:143], v[232:235]
    v_mfma_f32_16x16x32_bf16 v[236:239], v[44:47], v[140:143], v[236:239]
    v_mfma_f32_16x16x32_bf16 v[192:195], v[40:43], v[128:131], v[192:195]
    buffer_load_dwordx4 v148, s[12:15], s46 offen offset:0 lds
    v_mfma_f32_16x16x32_bf16 v[196:199], v[44:47], v[128:131], v[196:199]
    v_mfma_f32_16x16x32_bf16 v[224:227], v[40:43], v[132:135], v[224:227]
    v_mfma_f32_16x16x32_bf16 v[228:231], v[44:47], v[132:135], v[228:231]
    v_mfma_f32_16x16x32_bf16 v[16:19], v[178:181], a[224:227], v[200:203]
    buffer_load_dwordx4 v149, s[12:15], s46 offen offset:1024 lds
    v_mfma_f32_16x16x32_bf16 v[20:23], v[176:179], a[224:227], v[204:207]
    v_mfma_f32_16x16x32_bf16 v[24:27], v[178:181], a[228:231], v[232:235]
    v_mfma_f32_16x16x32_bf16 v[28:31], v[176:179], a[228:231], v[236:239]
    v_mfma_f32_16x16x32_bf16 v[32:35], v[178:181], a[232:235], v[192:195]
    buffer_load_dwordx4 v150, s[12:15], s46 offen offset:2048 lds
    v_mfma_f32_16x16x32_bf16 v[36:39], v[176:179], a[232:235], v[196:199]
    v_mfma_f32_16x16x32_bf16 v[40:43], v[178:181], a[236:239], v[224:227]
    v_mfma_f32_16x16x32_bf16 v[44:47], v[176:179], a[236:239], v[228:231]
    s_waitcnt vmcnt(9)
    v_swap_b32 v50, v52
    v_swap_b32 v51, v53
    s_nop 1
    v_mfma_f32_16x16x32_bf16 v[216:219], v[48:51], v[88:91], v[216:219]
    s_cbranch_scc1 L_nsw_4
    s_mov_b32 exec_lo, 0x10001
    s_mov_b32 exec_hi, 0x10001
    v_swap_b32 v224, v32
    v_swap_b32 v225, v33
    v_swap_b32 v226, v34
    v_swap_b32 v227, v35
    v_swap_b32 v228, v36
    v_swap_b32 v229, v37
    v_swap_b32 v230, v38
    v_swap_b32 v231, v39
    s_mov_b64 exec, -1
L_nsw_4:
    v_cndmask_b32 v200, v200, v185, s[56:57]
    v_cvt_pk_bf16_f32 v200, v200, v201
    v_mfma_f32_16x16x32_bf16 v[220:223], v[52:55], v[88:91], v[220:223]
    v_cvt_pk_bf16_f32 v201, v202, v203
    v_cvt_pk_bf16_f32 v202, v204, v205
    v_mfma_f32_16x16x32_bf16 v[248:251], v[48:51], v[92:95], v[248:251]
    buffer_load_dwordx4 v151, s[12:15], s46 offen offset:3072 lds
    v_mfma_f32_16x16x32_bf16 v[252:255], v[52:55], v[92:95], v[252:255]
    s_add_u32 m0, s1, 12288
    s_xor_b32 s46, s38, 2
    v_cvt_pk_bf16_f32 v203, v206, v207
    v_mfma_f32_16x16x32_bf16 v[208:211], v[48:51], v[80:83], v[208:211]
    s_mul_i32 s46, s46, 229376
    ds_write_b128 v10, v[200:203] offset:1024
    v_mfma_f32_16x16x32_bf16 v[212:215], v[52:55], v[80:83], v[212:215]
    s_sub_u32 s46, 1606144, s46
    v_mfma_f32_16x16x32_bf16 v[240:243], v[48:51], v[84:87], v[240:243]
    buffer_load_dwordx4 v152, s[12:15], s46 offen offset:0 lds
    v_mfma_f32_16x16x32_bf16 v[244:247], v[52:55], v[84:87], v[244:247]
    s_waitcnt vmcnt(9)
    v_swap_b32 v58, v60
    v_swap_b32 v59, v61
    v_cndmask_b32 v24, v24, v187, s[56:57]
    v_cvt_pk_bf16_f32 v204, v24, v25
    v_mfma_f32_16x16x32_bf16 v[216:219], v[56:59], v[104:107], v[216:219]
    v_cvt_pk_bf16_f32 v205, v26, v27
    v_cvt_pk_bf16_f32 v206, v28, v29
    v_mfma_f32_16x16x32_bf16 v[220:223], v[60:63], v[104:107], v[220:223]
    v_cvt_pk_bf16_f32 v207, v30, v31
    v_cvt_pk_bf16_f32 v232, v232, v233
    v_mfma_f32_16x16x32_bf16 v[248:251], v[56:59], v[108:111], v[248:251]
    ds_write_b128 v11, v[204:207] offset:1024
    v_mfma_f32_16x16x32_bf16 v[252:255], v[60:63], v[108:111], v[252:255]
    buffer_load_dwordx4 v153, s[12:15], s46 offen offset:1024 lds
    v_mfma_f32_16x16x32_bf16 v[24:27], v[200:203], v[200:203], 0
    v_cvt_pk_bf16_f32 v233, v234, v235
    v_cvt_pk_bf16_f32 v234, v236, v237
    v_mfma_f32_16x16x32_bf16 v[208:211], v[56:59], v[96:99], v[208:211]
    v_cvt_pk_bf16_f32 v235, v238, v239
    v_cvt_pk_bf16_f32 v236, v16, v17
    v_mfma_f32_16x16x32_bf16 v[212:215], v[60:63], v[96:99], v[212:215]
    ds_write_b128 v10, v[232:235] offset:9216
    v_mfma_f32_16x16x32_bf16 v[28:31], v[204:207], v[204:207], 0
    buffer_load_dwordx4 v154, s[12:15], s46 offen offset:2048 lds
    v_mfma_f32_16x16x32_bf16 v[240:243], v[56:59], v[100:103], v[240:243]
    v_cvt_pk_bf16_f32 v237, v18, v19
    v_cvt_pk_bf16_f32 v238, v20, v21
    v_mfma_f32_16x16x32_bf16 v[244:247], v[60:63], v[100:103], v[244:247]
    v_cvt_pk_bf16_f32 v239, v22, v23
    v_mov_b64 v[16:17], 0
    v_mfma_f32_16x16x32_bf16 v[24:27], v[232:235], v[232:235], v[24:27]
    s_waitcnt vmcnt(9)
    v_swap_b32 v66, v68
    v_swap_b32 v67, v69
    v_mov_b64 v[18:19], 0
    v_cndmask_b32 v192, v192, v184, s[56:57]
    v_mfma_f32_16x16x32_bf16 v[216:219], v[64:67], v[120:123], v[216:219]
    buffer_load_dwordx4 v155, s[12:15], s46 offen offset:3072 lds
    v_mfma_f32_16x16x32_bf16 v[220:223], v[68:71], v[120:123], v[220:223]
    s_add_u32 m0, s1, 16384
    ds_write_b128 v11, v[236:239] offset:9216
    v_mfma_f32_16x16x32_bf16 v[28:31], v[236:239], v[236:239], v[28:31]
    s_xor_b32 s46, s38, 3
    v_cvt_pk_bf16_f32 v192, v192, v193
    v_cvt_pk_bf16_f32 v193, v194, v195
    v_mfma_f32_16x16x32_bf16 v[248:251], v[64:67], v[124:127], v[248:251]
    s_mul_i32 s46, s46, 229376
    v_cvt_pk_bf16_f32 v194, v196, v197
    v_cvt_pk_bf16_f32 v195, v198, v199
    v_mfma_f32_16x16x32_bf16 v[252:255], v[68:71], v[124:127], v[252:255]
    s_add_u32 s46, s46, 114688
    ds_write_b128 v10, v[192:195] offset:0
    v_smfmac_f32_16x16x64_bf16 v[16:19], v[144:147], v[200:207], v191
    buffer_load_dwordx4 v148, s[12:15], s46 offen offset:0 lds
    v_mfma_f32_16x16x32_bf16 v[208:211], v[64:67], v[112:115], v[208:211]
    v_cndmask_b32 v40, v40, v186, s[56:57]
    v_cvt_pk_bf16_f32 v196, v40, v41
    v_mfma_f32_16x16x32_bf16 v[212:215], v[68:71], v[112:115], v[212:215]
    v_cvt_pk_bf16_f32 v197, v42, v43
    v_cvt_pk_bf16_f32 v198, v44, v45
    v_smfmac_f32_16x16x64_bf16 v[16:19], v[144:147], v[232:239], v191
    buffer_load_dwordx4 v149, s[12:15], s46 offen offset:1024 lds
    v_mfma_f32_16x16x32_bf16 v[240:243], v[64:67], v[116:119], v[240:243]
    v_cvt_pk_bf16_f32 v199, v46, v47
    v_cvt_pk_bf16_f32 v224, v224, v225
    v_mfma_f32_16x16x32_bf16 v[244:247], v[68:71], v[116:119], v[244:247]
    v_cvt_pk_bf16_f32 v225, v226, v227
    v_cvt_pk_bf16_f32 v226, v228, v229
    v_mfma_f32_16x16x32_bf16 v[40:43], v[192:195], v[192:195], 0
    s_waitcnt vmcnt(10)
    v_cvt_pk_bf16_f32 v227, v230, v231
    v_swap_b32 v74, v76
    v_swap_b32 v75, v77
    v_cvt_pk_bf16_f32 v228, v32, v33
    v_cvt_pk_bf16_f32 v229, v34, v35
    v_mfma_f32_16x16x32_bf16 v[216:219], v[72:75], v[136:139], v[216:219]
    ds_write_b128 v11, v[196:199] offset:0
    v_mfma_f32_16x16x32_bf16 v[220:223], v[76:79], v[136:139], v[220:223]
    buffer_load_dwordx4 v150, s[12:15], s46 offen offset:2048 lds
    v_mfma_f32_16x16x32_bf16 v[44:47], v[196:199], v[196:199], 0
    s_and_b32 s4, s41, 4
    v_cvt_pk_bf16_f32 v230, v36, v37
    v_cvt_pk_bf16_f32 v231, v38, v39
    v_mfma_f32_16x16x32_bf16 v[248:251], v[72:75], v[140:143], v[248:251]
    v_mov_b64 v[32:33], 0
    v_mov_b64 v[34:35], 0
    v_mfma_f32_16x16x32_bf16 v[252:255], v[76:79], v[140:143], v[252:255]
    buffer_load_dwordx4 v151, s[12:15], s46 offen offset:3072 lds
    v_mfma_f32_16x16x32_bf16 v[40:43], v[224:227], v[224:227], v[40:43]
    v_subrev_u32 v6, s37, v6
    v_cmp_ne_u64 vcc, v[6:7], v[4:5]
    v_mfma_f32_16x16x32_bf16 v[208:211], v[72:75], v[128:131], v[208:211]
    s_lshr_b32 s37, vcc_lo, s4
    ds_write_b128 v10, v[224:227] offset:8192
    v_mfma_f32_16x16x32_bf16 v[212:215], v[76:79], v[128:131], v[212:215]
    s_and_b32 s37, s37, 15
    s_cselect_b32 s37, 0, 1
    s_add_u32 m0, s1, 0
    v_mfma_f32_16x16x32_bf16 v[44:47], v[228:231], v[228:231], v[44:47]
    s_xor_b32 s46, s38, 3
    s_mul_i32 s46, s46, 229376
    s_sub_u32 s46, 1606144, s46
    v_mfma_f32_16x16x32_bf16 v[240:243], v[72:75], v[132:135], v[240:243]
    buffer_load_dwordx4 v152, s[12:15], s46 offen offset:0 lds
    v_mfma_f32_16x16x32_bf16 v[244:247], v[76:79], v[132:135], v[244:247]
    ds_write_b128 v11, v[228:231] offset:8192
    v_smfmac_f32_16x16x64_bf16 v[32:35], v[144:147], v[192:199], v191
    s_waitcnt lgkmcnt(0)
    s_barrier
    v_mfma_f32_16x16x32_bf16 v[48:51], v[178:181], a[240:243], v[216:219]
    s_cmp_lg_u32 s40, 0
    ds_read_b128 v[136:139], v8 offset:0
    ds_read_b128 v[140:143], v8 offset:1024
    v_mfma_f32_16x16x32_bf16 v[52:55], v[176:179], a[240:243], v[220:223]
    buffer_load_dwordx4 v153, s[12:15], s46 offen offset:1024 lds
    v_mfma_f32_16x16x32_bf16 v[56:59], v[178:181], a[244:247], v[248:251]
    ds_read_b128 v[200:203], v9 offset:0
    ds_read_b128 v[204:207], v9 offset:1024
    v_mfma_f32_16x16x32_bf16 v[60:63], v[176:179], a[244:247], v[252:255]
    s_waitcnt vmcnt(10)
    ds_read_b64_tr_b16 a[192:193], v156 offset:8192
    ds_read_b64_tr_b16 a[194:195], v156 offset:10240
    v_mfma_f32_16x16x32_bf16 v[64:67], v[178:181], a[248:251], v[208:211]
    ds_read_b64_tr_b16 a[196:197], v157 offset:8192
    ds_read_b64_tr_b16 a[198:199], v157 offset:10240
    v_mfma_f32_16x16x32_bf16 v[68:71], v[176:179], a[248:251], v[212:215]
    buffer_load_dwordx4 v154, s[12:15], s46 offen offset:2048 lds
    v_mfma_f32_16x16x32_bf16 v[72:75], v[178:181], a[252:255], v[240:243]
    ds_read_b64_tr_b16 a[200:201], v158 offset:8192
    ds_read_b64_tr_b16 a[202:203], v158 offset:10240
    v_mfma_f32_16x16x32_bf16 v[76:79], v[176:179], a[252:255], v[244:247]
    ds_read_b64_tr_b16 a[204:205], v159 offset:8192
    ds_read_b64_tr_b16 a[206:207], v159 offset:10240
    v_smfmac_f32_16x16x64_bf16 v[32:35], v[144:147], v[224:231], v191
    s_cbranch_scc1 L_nsw_5
    s_mov_b32 exec_lo, 0x10001
    s_mov_b32 exec_hi, 0x10001
    v_swap_b32 v240, v64
    v_swap_b32 v241, v65
    v_swap_b32 v242, v66
    v_swap_b32 v243, v67
    v_swap_b32 v244, v68
    v_swap_b32 v245, v69
    v_swap_b32 v246, v70
    v_swap_b32 v247, v71
    s_or_b32 s4, s2, s3
    s_cselect_b64 exec, 0, 1
    s_mov_b32 s4, 13660160
    buffer_store_dwordx2 v[4:5], off, s[24:27], s4 sc1
    s_mov_b64 exec, -1
L_nsw_5:
    s_mul_i32 s54, s41, 448
    s_waitcnt lgkmcnt(11)
    v_mfma_f32_16x16x32_bf16 v[80:83], a[0:3], v[136:139], 0
    buffer_load_dwordx4 v155, s[12:15], s46 offen offset:3072 lds
    v_mfma_f32_16x16x32_bf16 v[96:99], a[4:7], v[136:139], 0
    s_lshl_b32 s55, s3, 8
    s_mov_b64 exec, 0x1f
    buffer_load_dword v183, v14, s[28:31], s54 offen
    v_mfma_f32_16x16x32_bf16 v[112:115], a[8:11], v[136:139], 0
    s_mov_b64 exec, -1
    s_mov_b64 exec, 0x3
    s_waitcnt lgkmcnt(10)
    v_mfma_f32_16x16x32_bf16 v[128:131], a[12:15], v[136:139], 0
    buffer_load_dword v183, v14, s[32:35], s55 offen
    v_mfma_f32_16x16x32_bf16 v[84:87], a[0:3], v[140:143], 0
    s_mov_b64 exec, -1
    s_waitcnt lgkmcnt(0)
    s_mov_b64 exec, 0x1
    v_mfma_f32_16x16x32_bf16 v[100:103], a[4:7], v[140:143], 0
    buffer_load_dword v183, v14, s[24:27], s101 offen sc1
    v_mfma_f32_16x16x32_bf16 v[116:119], a[8:11], v[140:143], 0
    s_mov_b64 exec, -1
    s_lshr_b32 s46, s41, 2
    s_lshl_b32 s46, s46, 7
    v_smfmac_f32_16x16x64_bf16 v[160:163], v[144:147], a[192:199], v191
    s_add_u32 s59, s44, s46
    s_mul_i32 s59, s59, 7168
    s_mov_b32 exec_hi, 0xffffff
    v_mfma_f32_16x16x32_bf16 v[132:135], a[12:15], v[140:143], 0
    buffer_load_dword v183, v14, s[16:19], s59 offen
    v_smfmac_f32_16x16x64_bf16 v[168:171], v[144:147], a[200:207], v191
    s_mov_b64 exec, -1
    s_mul_i32 s45, s3, 57344
    ds_read_b128 v[232:235], v8 offset:8192
    v_mfma_f32_16x16x32_bf16 v[88:91], a[0:3], v[200:203], 0
    s_add_u32 s45, s45, 8192
    ds_read_b128 v[236:239], v8 offset:9216
    v_lshlrev_b32 v148, 1, v2
    v_mfma_f32_16x16x32_bf16 v[104:107], a[4:7], v[200:203], 0
    s_and_b32 s45, s45, 0xffffc000
    v_xor_b32 v148, v148, v0
    v_and_b32 v148, 7, v148
    v_mfma_f32_16x16x32_bf16 v[120:123], a[8:11], v[200:203], 0
    s_lshl_b32 s46, s41, 7
    v_lshrrev_b32 v149, 3, v0
    v_lshlrev_b32 v149, 10, v149
    v_mfma_f32_16x16x32_bf16 v[92:95], a[0:3], v[204:207], 0
    s_add_u32 s45, s45, s46
    ds_read_b128 v[192:195], v9 offset:8192
    v_lshl_add_u32 v148, v148, 4, v149
    v_mfma_f32_16x16x32_bf16 v[108:111], a[4:7], v[204:207], 0
    s_waitcnt vmcnt(12)
    ds_read_b128 v[196:199], v9 offset:9216
    v_add_u32 v149, 7168, v148
    v_mfma_f32_16x16x32_bf16 v[124:127], a[8:11], v[204:207], 0
    s_waitcnt lgkmcnt(3)
    ds_read_b64_tr_b16 a[208:209], v156 offset:12288
    ds_read_b64_tr_b16 a[210:211], v156 offset:14336
    v_mfma_f32_16x16x32_bf16 v[80:83], a[16:19], v[232:235], v[80:83]
    s_waitcnt lgkmcnt(4)
    ds_read_b64_tr_b16 a[212:213], v157 offset:12288
    ds_read_b64_tr_b16 a[214:215], v157 offset:14336
    v_mfma_f32_16x16x32_bf16 v[96:99], a[20:23], v[232:235], v[96:99]
    ds_read_b64_tr_b16 a[216:217], v158 offset:12288
    ds_read_b64_tr_b16 a[218:219], v158 offset:14336
    v_mfma_f32_16x16x32_bf16 v[112:115], a[24:27], v[232:235], v[112:115]
    v_xor_b32 v8, 16384, v8
    v_xor_b32 v9, 16384, v9
    v_mfma_f32_16x16x32_bf16 v[128:131], a[28:31], v[232:235], v[128:131]
    ds_read_b128 v[224:227], v8 offset:0
    v_cvt_pk_bf16_f32 v216, v216, v217
    v_mfma_f32_16x16x32_bf16 v[84:87], a[16:19], v[236:239], v[84:87]
    ds_read_b128 v[228:231], v8 offset:1024
    v_cvt_pk_bf16_f32 v217, v218, v219
    v_mfma_f32_16x16x32_bf16 v[100:103], a[20:23], v[236:239], v[100:103]
    ds_read_b128 v[136:139], v9 offset:0
    v_cvt_pk_bf16_f32 v218, v220, v221
    v_mfma_f32_16x16x32_bf16 v[116:119], a[24:27], v[236:239], v[116:119]
    s_waitcnt vmcnt(8)
    ds_read_b128 v[140:143], v9 offset:1024
    v_cvt_pk_bf16_f32 v219, v222, v223
    v_mfma_f32_16x16x32_bf16 v[132:135], a[28:31], v[236:239], v[132:135]
    s_waitcnt lgkmcnt(9)
    ds_read_b64_tr_b16 a[220:221], v159 offset:12288
    ds_read_b64_tr_b16 a[222:223], v159 offset:14336
    v_mfma_f32_16x16x32_bf16 v[88:91], a[16:19], v[192:195], v[88:91]
    ds_read_b64_tr_b16 a[224:225], v156 offset:16384
    ds_read_b64_tr_b16 a[226:227], v156 offset:18432
    v_mfma_f32_16x16x32_bf16 v[104:107], a[20:23], v[192:195], v[104:107]
    ds_read_b64_tr_b16 a[228:229], v157 offset:16384
    ds_read_b64_tr_b16 a[230:231], v157 offset:18432
    v_mfma_f32_16x16x32_bf16 v[120:123], a[24:27], v[192:195], v[120:123]
    ds_read_b64_tr_b16 a[232:233], v158 offset:16384
    ds_read_b64_tr_b16 a[234:235], v158 offset:18432
    v_mfma_f32_16x16x32_bf16 v[92:95], a[16:19], v[196:199], v[92:95]
    ds_read_b64_tr_b16 a[236:237], v159 offset:16384
    ds_read_b64_tr_b16 a[238:239], v159 offset:18432
    v_mfma_f32_16x16x32_bf16 v[24:27], v[216:219], v[216:219], v[24:27]
    s_waitcnt lgkmcnt(8)
    ds_write_b128 v10, v[216:219] offset:5120
    v_mfma_f32_16x16x32_bf16 v[108:111], a[20:23], v[196:199], v[108:111]
    v_cvt_pk_bf16_f32 v220, v56, v57
    v_cvt_pk_bf16_f32 v221, v58, v59
    v_cvt_pk_bf16_f32 v222, v60, v61
    v_smfmac_f32_16x16x64_bf16 v[160:163], v[144:147], a[208:215], v191
    v_cvt_pk_bf16_f32 v223, v62, v63
    v_mfma_f32_16x16x32_bf16 v[124:127], a[24:27], v[196:199], v[124:127]
    ds_write_b128 v11, v[220:223] offset:5120
    v_mfma_f32_16x16x32_bf16 v[28:31], v[220:223], v[220:223], v[28:31]
    s_waitcnt lgkmcnt(2)
    v_cvt_pk_bf16_f32 v248, v248, v249
    v_cvt_pk_bf16_f32 v249, v250, v251
    v_mfma_f32_16x16x32_bf16 v[80:83], a[32:35], v[224:227], v[80:83]
    ds_read_b128 v[200:203], v8 offset:8192
    ds_read_b128 v[204:207], v8 offset:9216
    v_smfmac_f32_16x16x64_bf16 v[16:19], v[144:147], v[216:223], v191
    v_cvt_pk_bf16_f32 v250, v252, v253
    v_mfma_f32_16x16x32_bf16 v[96:99], a[36:39], v[224:227], v[96:99]
    ds_read_b128 v[56:59], v9 offset:8192
    ds_read_b128 v[60:63], v9 offset:9216
    v_smfmac_f32_16x16x64_bf16 v[168:171], v[144:147], a[216:223], v191
    v_cvt_pk_bf16_f32 v251, v254, v255
    v_mfma_f32_16x16x32_bf16 v[112:115], a[40:43], v[224:227], v[112:115]
    v_xor_b32 v8, 49152, v8
    v_xor_b32 v9, 49152, v9
    v_smfmac_f32_16x16x64_bf16 v[160:163], v[144:147], a[224:231], v191
    ds_read_b128 v[232:235], v8 offset:0
    v_mfma_f32_16x16x32_bf16 v[128:131], a[44:47], v[224:227], v[128:131]
    s_waitcnt vmcnt(4)
    ds_read_b128 v[236:239], v8 offset:1024
    v_cvt_pk_bf16_f32 v252, v48, v49
    v_smfmac_f32_16x16x64_bf16 v[168:171], v[144:147], a[232:239], v191
    ds_read_b128 v[192:195], v9 offset:0
    v_mfma_f32_16x16x32_bf16 v[84:87], a[32:35], v[228:231], v[84:87]
    ds_read_b128 v[196:199], v9 offset:1024
    v_cvt_pk_bf16_f32 v253, v50, v51
    v_mfma_f32_16x16x32_bf16 v[100:103], a[36:39], v[228:231], v[100:103]
    ds_write_b128 v10, v[248:251] offset:13312
    v_mfma_f32_16x16x32_bf16 v[116:119], a[40:43], v[228:231], v[116:119]
    v_cvt_pk_bf16_f32 v254, v52, v53
    v_cvt_pk_bf16_f32 v255, v54, v55
    v_mfma_f32_16x16x32_bf16 v[24:27], v[248:251], v[248:251], v[24:27]
    ds_read_b64_tr_b16 a[240:241], v156 offset:0
    ds_read_b64_tr_b16 a[242:243], v156 offset:2048
    v_mfma_f32_16x16x32_bf16 v[132:135], a[44:47], v[228:231], v[132:135]
    ds_read_b64_tr_b16 a[244:245], v157 offset:0
    ds_read_b64_tr_b16 a[246:247], v157 offset:2048
    v_mfma_f32_16x16x32_bf16 v[88:91], a[32:35], v[136:139], v[88:91]
    ds_read_b64_tr_b16 a[248:249], v158 offset:0
    ds_read_b64_tr_b16 a[250:251], v158 offset:2048
L_pad3:
    s_cbranch_execz L_retB
    v_mfma_f32_16x16x32_bf16 v[104:107], a[36:39], v[136:139], v[104:107]
    ds_read_b64_tr_b16 a[252:253], v159 offset:0
    ds_read_b64_tr_b16 a[254:255], v159 offset:2048
    v_mfma_f32_16x16x32_bf16 v[28:31], v[252:255], v[252:255], v[28:31]
    ds_write_b128 v11, v[252:255] offset:13312
    v_mfma_f32_16x16x32_bf16 v[120:123], a[40:43], v[136:139], v[120:123]
    v_cvt_pk_bf16_f32 v208, v208, v209
    v_cvt_pk_bf16_f32 v209, v210, v211
    v_cvt_pk_bf16_f32 v210, v212, v213
    v_smfmac_f32_16x16x64_bf16 v[16:19], v[144:147], v[248:255], v191
    v_cvt_pk_bf16_f32 v211, v214, v215
    v_mfma_f32_16x16x32_bf16 v[92:95], a[32:35], v[140:143], v[92:95]
    ds_write_b128 v10, v[208:211] offset:4096
    v_mfma_f32_16x16x32_bf16 v[40:43], v[208:211], v[208:211], v[40:43]
    s_waitcnt lgkmcnt(2)
    v_cvt_pk_bf16_f32 v212, v72, v73
    v_cvt_pk_bf16_f32 v213, v74, v75
    v_mfma_f32_16x16x32_bf16 v[108:111], a[36:39], v[140:143], v[108:111]
    s_add_u32 m0, s1, 4096
    v_cvt_pk_bf16_f32 v214, v76, v77
    v_cvt_pk_bf16_f32 v215, v78, v79
    v_smfmac_f32_16x16x64_bf16 v[160:163], v[144:147], a[240:247], v191
    s_mul_i32 s46, s41, 229376
    s_add_u32 s46, s46, s45
    v_cvt_pk_bf16_f32 v240, v240, v241
    v_mfma_f32_16x16x32_bf16 v[124:127], a[40:43], v[140:143], v[124:127]
    ds_write_b128 v11, v[212:215] offset:4096
    v_mfma_f32_16x16x32_bf16 v[44:47], v[212:215], v[212:215], v[44:47]
    v_cvt_pk_bf16_f32 v241, v242, v243
    v_cvt_pk_bf16_f32 v242, v244, v245
    v_mfma_f32_16x16x32_bf16 v[80:83], a[48:51], v[200:203], v[80:83]
    v_cvt_pk_bf16_f32 v243, v246, v247
    v_smfmac_f32_16x16x64_bf16 v[32:35], v[144:147], v[208:215], v191
    v_mfma_f32_16x16x32_bf16 v[96:99], a[52:55], v[200:203], v[96:99]
    s_xor_b32 s46, s46, 512
    ds_write_b128 v10, v[240:243] offset:12288
    v_smfmac_f32_16x16x64_bf16 v[168:171], v[144:147], a[248:255], v191
    buffer_load_dwordx4 v148, s[16:19], s46 offen offset:0 lds
    v_mfma_f32_16x16x32_bf16 v[112:115], a[56:59], v[200:203], v[112:115]
    ds_read_b128 v[216:219], v8 offset:8192
    ds_read_b128 v[220:223], v8 offset:9216
    v_mfma_f32_16x16x32_bf16 v[128:131], a[60:63], v[200:203], v[128:131]
    s_lshl_b32 s4, s43, 10
    ds_read_b128 v[48:51], v9 offset:8192
    v_xor_b32 v8, 16384, v8
    v_mfma_f32_16x16x32_bf16 v[84:87], a[48:51], v[204:207], v[84:87]
    s_lshl3_add_u32 s4, s3, s4
    ds_read_b128 v[52:55], v9 offset:9216
    v_xor_b32 v9, 16384, v9
    v_mfma_f32_16x16x32_bf16 v[100:103], a[52:55], v[204:207], v[100:103]
    buffer_load_dwordx4 v149, s[16:19], s46 offen offset:1024 lds
    v_mfma_f32_16x16x32_bf16 v[116:119], a[56:59], v[204:207], v[116:119]
    s_add_u32 s4, s4, 157696
    ds_read_b128 v[248:251], v8 offset:0
    v_cvt_pk_bf16_f32 v244, v64, v65
    v_mfma_f32_16x16x32_bf16 v[40:43], v[240:243], v[240:243], v[40:43]
    s_add_u32 s46, s46, 14336
    ds_read_b128 v[252:255], v8 offset:1024
    v_cvt_pk_bf16_f32 v245, v66, v67
    v_mfma_f32_16x16x32_bf16 v[132:135], a[60:63], v[204:207], v[132:135]
    ds_read_b128 v[72:75], v9 offset:0
    v_cvt_pk_bf16_f32 v246, v68, v69
    v_mfma_f32_16x16x32_bf16 v[88:91], a[48:51], v[56:59], v[88:91]
    ds_read_b128 v[76:79], v9 offset:1024
    v_cvt_pk_bf16_f32 v247, v70, v71
    v_lshl_add_u32 v6, v1, 5, s4
    v_xor_b32 v7, 1024, v6
    v_mfma_f32_16x16x32_bf16 v[44:47], v[244:247], v[244:247], v[44:47]
    v_cndmask_b32 v24, v24, v25, s[48:49]
    v_cndmask_b32 v26, v26, v27, s[48:49]
    v_mfma_f32_16x16x32_bf16 v[104:107], a[52:55], v[56:59], v[104:107]
    v_cndmask_b32 v23, v24, v26, s[50:51]
    v_cndmask_b32 v28, v28, v29, s[48:49]
    v_smfmac_f32_16x16x64_bf16 v[32:35], v[144:147], v[240:247], v191
    v_cndmask_b32 v30, v30, v31, s[48:49]
    v_mfma_f32_16x16x32_bf16 v[120:123], a[56:59], v[56:59], v[120:123]
    v_cndmask_b32 v21, v28, v30, s[50:51]
    v_add_f32 v20, v18, v19
    v_mfma_f32_16x16x32_bf16 v[92:95], a[48:51], v[60:63], v[92:95]
    ds_write_b128 v11, v[244:247] offset:12288
    v_add_f32 v22, v16, v17
    v_mfma_f32_16x16x32_bf16 v[108:111], a[52:55], v[60:63], v[108:111]
    buffer_load_dwordx4 v148, s[16:19], s46 offen offset:2048 lds
    v_cndmask_b32 v40, v40, v41, s[48:49]
    v_cndmask_b32 v42, v42, v43, s[48:49]
    v_cndmask_b32 v39, v40, v42, s[50:51]
    v_cndmask_b32 v44, v44, v45, s[48:49]
    v_cndmask_b32 v46, v46, v47, s[48:49]
    v_cndmask_b32 v37, v44, v46, s[50:51]
    v_add_f32 v36, v34, v35
    v_add_f32 v38, v32, v33
    v_mfma_f32_16x16x32_bf16 v[124:127], a[56:59], v[60:63], v[124:127]
    s_mov_b64 exec, s[60:61]
    ds_write_b64 v6, v[38:39] offset:0
    ds_write_b64 v6, v[22:23] offset:512
    ds_write_b64 v7, v[36:37] offset:0
    v_mfma_f32_16x16x32_bf16 v[80:83], a[64:67], v[232:235], v[80:83]
    ds_write_b64 v7, v[20:21] offset:512
    v_mfma_f32_16x16x32_bf16 v[96:99], a[68:71], v[232:235], v[96:99]
    s_mov_b64 exec, -1
    ds_read_b128 v[224:227], v8 offset:8192
    ds_read_b128 v[228:231], v8 offset:9216
    v_mfma_f32_16x16x32_bf16 v[112:115], a[72:75], v[232:235], v[112:115]
    buffer_load_dwordx4 v149, s[16:19], s46 offen offset:3072 lds
    v_mfma_f32_16x16x32_bf16 v[128:131], a[76:79], v[232:235], v[128:131]
    s_and_b32 s59, s3, 2
    ds_read_b128 v[136:139], v9 offset:8192
    ds_read_b128 v[140:143], v9 offset:9216
    v_mfma_f32_16x16x32_bf16 v[84:87], a[64:67], v[236:239], v[84:87]
    s_lshl_b32 s59, s59, 5
    v_xor_b32 v155, s59, v156
    v_xor_b32 v152, 96, v155
    v_mfma_f32_16x16x32_bf16 v[100:103], a[68:71], v[236:239], v[100:103]
    s_waitcnt lgkmcnt(4)
    s_barrier
    v_xor_b32 v8, 49152, v8
    v_mfma_f32_16x16x32_bf16 v[116:119], a[72:75], v[236:239], v[116:119]
    s_add_u32 m0, s1, 8192
    ds_read_b128 v[208:211], v8 offset:4096
    s_mul_i32 s46, s41, 229376
    v_mfma_f32_16x16x32_bf16 v[132:135], a[76:79], v[236:239], v[132:135]
    s_add_u32 s46, s46, s45
    ds_read_b128 v[212:215], v8 offset:5120
    v_xor_b32 v9, 49152, v9
    v_mfma_f32_16x16x32_bf16 v[88:91], a[64:67], v[192:195], v[88:91]
    s_lshl_b32 s6, s43, 10
    ds_read_b128 v[64:67], v9 offset:4096
    ds_read_b128 v[68:71], v9 offset:5120
    v_mfma_f32_16x16x32_bf16 v[104:107], a[68:71], v[192:195], v[104:107]
    buffer_load_dwordx4 v148, s[16:19], s46 offen offset:0 lds
    v_mfma_f32_16x16x32_bf16 v[120:123], a[72:75], v[192:195], v[120:123]
    buffer_load_dwordx4 v149, s[16:19], s46 offen offset:1024 lds
    v_mfma_f32_16x16x32_bf16 v[92:95], a[64:67], v[196:199], v[92:95]
    s_add_u32 s46, s46, 14336
    ds_read_b128 v[240:243], v8 offset:12288
    v_xor_b32 v8, 16384, v8
    v_mfma_f32_16x16x32_bf16 v[108:111], a[68:71], v[196:199], v[108:111]
    s_add_u32 s6, s6, 157696
    ds_read_b128 v[244:247], v8 offset:4096
    ds_read_b128 v[200:203], v8 offset:12288
    v_mfma_f32_16x16x32_bf16 v[124:127], a[72:75], v[196:199], v[124:127]
    s_mul_i32 s4, s41, 448
    v_xor_b32 v8, 49152, v8
    v_xor_b32 v153, 64, v155
    v_mfma_f32_16x16x32_bf16 v[80:83], a[80:83], v[216:219], v[80:83]
    s_lshr_b32 s5, s3, 1
    ds_read_b128 v[204:207], v8 offset:4096
    ds_read_b128 v[56:59], v8 offset:12288
    v_mfma_f32_16x16x32_bf16 v[96:99], a[84:87], v[216:219], v[96:99]
    buffer_load_dwordx4 v148, s[16:19], s46 offen offset:2048 lds
    v_mfma_f32_16x16x32_bf16 v[112:115], a[88:91], v[216:219], v[112:115]
    s_mul_i32 s5, s5, 224
    v_xor_b32 v154, 32, v155
    v_xor_b32 v8, 16384, v8
    v_mfma_f32_16x16x32_bf16 v[128:131], a[92:95], v[216:219], v[128:131]
    s_add_u32 s4, s4, s5
    ds_read_b128 v[60:63], v8 offset:4096
    v_lshlrev_b32 v184, 5, v0
    v_mfma_f32_16x16x32_bf16 v[84:87], a[80:83], v[220:223], v[84:87]
    s_lshl_b32 s5, s43, 7
    ds_read_b128 v[232:235], v8 offset:12288
    ds_read_b128 v[236:239], v8 offset:13312
    v_mfma_f32_16x16x32_bf16 v[100:103], a[84:87], v[220:223], v[100:103]
    buffer_load_dwordx4 v149, s[16:19], s46 offen offset:3072 lds
    v_xor_b32 v184, s6, v184
    v_mfma_f32_16x16x32_bf16 v[116:119], a[88:91], v[220:223], v[116:119]
    s_add_u32 s5, s5, s4
    ds_read_b128 v[44:47], v184
    v_lshlrev_b32 v182, 1, v1
    v_mfma_f32_16x16x32_bf16 v[132:135], a[92:95], v[220:223], v[132:135]
    buffer_load_ushort v24, v182, s[28:31], s5 offen offset:0
    v_mfma_f32_16x16x32_bf16 v[88:91], a[80:83], v[48:51], v[88:91]
    buffer_load_ushort v25, v182, s[28:31], s5 offen offset:32
    v_mfma_f32_16x16x32_bf16 v[104:107], a[84:87], v[48:51], v[104:107]
    s_add_u32 m0, s1, 12288
    ds_read_b128 v[28:31], v184 offset:16
    s_xor_b32 s46, s41, 1
    v_mfma_f32_16x16x32_bf16 v[120:123], a[88:91], v[48:51], v[120:123]
    buffer_load_ushort v26, v182, s[28:31], s5 offen offset:64
    v_mfma_f32_16x16x32_bf16 v[92:95], a[80:83], v[52:55], v[92:95]
    buffer_load_ushort v27, v182, s[28:31], s4 offen offset:96
    v_mfma_f32_16x16x32_bf16 v[108:111], a[84:87], v[52:55], v[108:111]
    s_waitcnt lgkmcnt(0)
    v_mfma_f32_16x16x32_bf16 v[124:127], a[88:91], v[52:55], v[124:127]
    s_mul_i32 s46, s46, 229376
    ds_read_b128 v[192:195], v8 offset:5120
    s_add_u32 s46, s46, s45
    v_mfma_f32_16x16x32_bf16 v[80:83], a[96:99], v[248:251], v[80:83]
    s_xor_b32 s46, s46, 512
    v_add_f32 v44, v44, v46
    v_xor_b32 v8, 16384, v8
    v_mfma_f32_16x16x32_bf16 v[96:99], a[100:103], v[248:251], v[96:99]
    buffer_load_dwordx4 v148, s[16:19], s46 offen offset:0 lds
    v_mfma_f32_16x16x32_bf16 v[112:115], a[104:107], v[248:251], v[112:115]
    buffer_load_dwordx4 v149, s[16:19], s46 offen offset:1024 lds
    v_mfma_f32_16x16x32_bf16 v[128:131], a[108:111], v[248:251], v[128:131]
    ds_read_b128 v[196:199], v8 offset:13312
    ds_read_b128 v[216:219], v8 offset:5120
    v_mfma_f32_16x16x32_bf16 v[84:87], a[96:99], v[252:255], v[84:87]
    s_add_u32 s46, s46, 14336
    v_xor_b32 v8, 49152, v8
    v_add_f32 v45, v45, v47
    v_mfma_f32_16x16x32_bf16 v[100:103], a[100:103], v[252:255], v[100:103]
    buffer_load_dwordx4 v148, s[16:19], s46 offen offset:2048 lds
    v_mfma_f32_16x16x32_bf16 v[116:119], a[104:107], v[252:255], v[116:119]
    v_add_f32 v28, v28, v30
    v_add_f32 v29, v29, v31
    v_mfma_f32_16x16x32_bf16 v[132:135], a[108:111], v[252:255], v[132:135]
    v_add_f32 v44, v44, v28
    v_add_f32 v45, v45, v29
    v_mfma_f32_16x16x32_bf16 v[88:91], a[96:99], v[72:75], v[88:91]
    buffer_load_dwordx4 v149, s[16:19], s46 offen offset:3072 lds
    v_mfma_f32_16x16x32_bf16 v[104:107], a[100:103], v[72:75], v[104:107]
    s_add_u32 m0, s1, 16384
    ds_read_b128 v[220:223], v8 offset:13312
    v_mul_f32 v44, 0xbb000000, v44
    v_mfma_f32_16x16x32_bf16 v[120:123], a[104:107], v[72:75], v[120:123]
    s_xor_b32 s46, s41, 2
    v_mul_f32 v45, 0x3b000000, v45
    v_fma_f32 v45, -v44, v44, v45
    v_mfma_f32_16x16x32_bf16 v[92:95], a[96:99], v[76:79], v[92:95]
    s_mul_i32 s46, s46, 229376
    v_max_f32 v45, 0, v45
    v_add_f32 v45, 0x3727c5ac, v45
    v_mfma_f32_16x16x32_bf16 v[108:111], a[100:103], v[76:79], v[108:111]
    s_add_u32 s46, s46, s45
    v_rcp_f32 v40, v45
    v_mfma_f32_16x16x32_bf16 v[124:127], a[104:107], v[76:79], v[124:127]
    s_xor_b32 s46, s46, 512
    v_sqrt_f32 v45, v45
    v_mfma_f32_16x16x32_bf16 v[80:83], a[112:115], v[224:227], v[80:83]
    buffer_load_dwordx4 v148, s[16:19], s46 offen offset:0 lds
    v_mfma_f32_16x16x32_bf16 v[96:99], a[116:119], v[224:227], v[96:99]
    ds_read_b128 v[48:51], v8 offset:5120
    v_mov_b32 v42, v40
    v_mfma_f32_16x16x32_bf16 v[112:115], a[120:123], v[224:227], v[112:115]
    v_cvt_pk_bf16_f32 v28, v44, v45
    v_lshlrev_b32 v46, 16, v28
    v_xor_b32 v8, 16384, v8
    v_mfma_f32_16x16x32_bf16 v[128:131], a[124:127], v[224:227], v[128:131]
    buffer_load_dwordx4 v149, s[16:19], s46 offen offset:1024 lds
    ds_read_b128 v[52:55], v8 offset:13312
    v_mfma_f32_16x16x32_bf16 v[84:87], a[112:115], v[228:231], v[84:87]
    s_waitcnt vmcnt(14)
    ds_read_b128 v[248:251], v9 offset:12288
    v_xor_b32 v9, 16384, v9
    v_mfma_f32_16x16x32_bf16 v[100:103], a[116:119], v[228:231], v[100:103]
    ds_read_b128 v[252:255], v9 offset:4096
    ds_read_b64_tr_b16 a[0:1], v152 offset:4096
    v_mfma_f32_16x16x32_bf16 v[116:119], a[120:123], v[228:231], v[116:119]
    s_add_u32 s46, s46, 14336
    ds_read_b64_tr_b16 a[2:3], v152 offset:6144
    ds_read_b64_tr_b16 a[4:5], v153 offset:4096
    v_mfma_f32_16x16x32_bf16 v[132:135], a[124:127], v[228:231], v[132:135]
    buffer_load_dwordx4 v148, s[16:19], s46 offen offset:2048 lds
    v_mfma_f32_16x16x32_bf16 v[88:91], a[112:115], v[136:139], v[88:91]
    ds_read_b64_tr_b16 a[6:7], v153 offset:6144
    ds_read_b64_tr_b16 a[8:9], v154 offset:4096
    v_mfma_f32_16x16x32_bf16 v[104:107], a[116:119], v[136:139], v[104:107]
    ds_read_b64_tr_b16 a[10:11], v154 offset:6144
    ds_read_b64_tr_b16 a[12:13], v155 offset:4096
    v_mfma_f32_16x16x32_bf16 v[120:123], a[120:123], v[136:139], v[120:123]
    buffer_load_dwordx4 v149, s[16:19], s46 offen offset:3072 lds
    v_mfma_f32_16x16x32_bf16 v[92:95], a[112:115], v[140:143], v[92:95]
    s_add_u32 m0, s1, 0
    ds_read_b64_tr_b16 a[14:15], v155 offset:6144
    ds_read_b128 v[72:75], v9 offset:12288
    v_mfma_f32_16x16x32_bf16 v[108:111], a[116:119], v[140:143], v[108:111]
    s_xor_b32 s46, s41, 3
    v_and_b32 v47, 0xffff0000, v28
    v_sub_f32 v46, v44, v46
    v_mfma_f32_16x16x32_bf16 v[124:127], a[120:123], v[140:143], v[124:127]
    s_mul_i32 s46, s46, 229376
    v_sub_f32 v47, v45, v47
    v_cvt_pk_bf16_f32 v29, v46, v47
    v_mfma_f32_16x16x32_bf16 v[80:83], a[128:131], v[208:211], v[80:83]
    s_add_u32 s46, s46, s45
    v_and_b32 v30, 0xffff, v28
    v_permlane32_swap_b32 v40, v42
    v_mfma_f32_16x16x32_bf16 v[96:99], a[132:135], v[208:211], v[96:99]
    s_xor_b32 s46, s46, 512
    v_mov_b32 v41, v40
    v_mov_b32 v43, v42
    v_xor_b32 v9, 49152, v9
    v_mfma_f32_16x16x32_bf16 v[112:115], a[136:139], v[208:211], v[112:115]
    buffer_load_dwordx4 v148, s[16:19], s46 offen offset:0 lds
    ds_read_b128 v[76:79], v9 offset:4096
    v_mfma_f32_16x16x32_bf16 v[128:131], a[140:143], v[208:211], v[128:131]
    ds_read_b128 v[224:227], v9 offset:12288
    v_xor_b32 v9, 16384, v9
    v_mfma_f32_16x16x32_bf16 v[84:87], a[128:131], v[212:215], v[84:87]
    s_waitcnt vmcnt(13)
    ds_read_b128 v[228:231], v9 offset:4096
    ds_read_b64_tr_b16 a[16:17], v152 offset:8192
    v_mfma_f32_16x16x32_bf16 v[100:103], a[132:135], v[212:215], v[100:103]
    buffer_load_dwordx4 v149, s[16:19], s46 offen offset:1024 lds
    ds_read_b64_tr_b16 a[18:19], v152 offset:10240
    v_mfma_f32_16x16x32_bf16 v[116:119], a[136:139], v[212:215], v[116:119]
    s_add_u32 s46, s46, 14336
    ds_read_b64_tr_b16 a[20:21], v153 offset:8192
    ds_read_b64_tr_b16 a[22:23], v153 offset:10240
    v_mfma_f32_16x16x32_bf16 v[132:135], a[140:143], v[212:215], v[132:135]
    ds_read_b64_tr_b16 a[24:25], v154 offset:8192
    ds_read_b64_tr_b16 a[26:27], v154 offset:10240
    v_mfma_f32_16x16x32_bf16 v[88:91], a[128:131], v[64:67], v[88:91]
    ds_read_b64_tr_b16 a[28:29], v155 offset:8192
    ds_read_b64_tr_b16 a[30:31], v155 offset:10240
    v_mfma_f32_16x16x32_bf16 v[104:107], a[132:135], v[64:67], v[104:107]
    buffer_load_dwordx4 v148, s[16:19], s46 offen offset:2048 lds
    v_mfma_f32_16x16x32_bf16 v[120:123], a[136:139], v[64:67], v[120:123]
    v_permlane16_swap_b32 v40, v41
    v_mfma_f32_16x16x32_bf16 v[92:95], a[128:131], v[68:71], v[92:95]
    v_permlane16_swap_b32 v42, v43
    v_cmp_eq_u32 vcc, 0, v2
    v_mfma_f32_16x16x32_bf16 v[108:111], a[132:135], v[68:71], v[108:111]
    buffer_load_dwordx4 v149, s[16:19], s46 offen offset:3072 lds
    v_mov_b32 v35, 0
    v_cndmask_b32 v32, 0, v28, vcc
    v_cndmask_b32 v33, 0, v29, vcc
    v_mfma_f32_16x16x32_bf16 v[124:127], a[136:139], v[68:71], v[124:127]
    s_add_u32 m0, s1, 4096
    v_cndmask_b32 v34, 0, v30, vcc
    v_cmp_eq_u32 vcc, 1, v2
    v_mfma_f32_16x16x32_bf16 v[80:83], a[144:147], v[240:243], v[80:83]
    s_mul_i32 s46, s41, 229376
    v_mov_b32 v19, 0
    v_cndmask_b32 v16, 0, v28, vcc
    v_mfma_f32_16x16x32_bf16 v[80:83], a[160:163], v[244:247], v[80:83]
    s_add_u32 s46, s46, s45
    v_cndmask_b32 v17, 0, v29, vcc
    v_cndmask_b32 v18, 0, v30, vcc
    v_mfma_f32_16x16x32_bf16 v[80:83], a[176:179], v[200:203], v[80:83]
    s_add_u32 s46, s46, 32768
    v_cmp_eq_u32 vcc, 2, v2
    v_mov_b32 v39, 0
    v_mfma_f32_16x16x32_bf16 v[80:83], a[192:195], v[204:207], v[80:83]
    s_xor_b32 s46, s46, 512
    v_cndmask_b32 v36, 0, v28, vcc
    v_cndmask_b32 v37, 0, v29, vcc
    v_mfma_f32_16x16x32_bf16 v[80:83], a[208:211], v[56:59], v[80:83]
    s_waitcnt lgkmcnt(12)
    v_cndmask_b32 v38, 0, v30, vcc
    v_cmp_eq_u32 vcc, 3, v2
    v_mfma_f32_16x16x32_bf16 v[80:83], a[224:227], v[60:63], v[80:83]
    buffer_load_dwordx4 v148, s[16:19], s46 offen offset:0 lds
    v_mfma_f32_16x16x32_bf16 v[80:83], a[240:243], v[232:235], v[80:83]
    s_waitcnt vmcnt(13)
    v_mov_b32 v23, 0
    v_cndmask_b32 v20, 0, v28, vcc
    v_cndmask_b32 v21, 0, v29, vcc
    v_cndmask_b32 v22, 0, v30, vcc
    v_add_f32 v166, v162, v163
    v_add_f32 v162, v160, v161
    v_lshlrev_b32 v163, 16, v24
    v_cvt_pk_bf16_f32 v160, v162, v163
    v_lshlrev_b32 v163, 16, v160
    v_sub_f32 v162, v162, v163
    v_mov_b32 v161, v160
    v_cvt_pk_bf16_f32 v162, v162, 0
    v_mov_b32 v163, 0
    v_lshlrev_b32 v167, 16, v25
    v_cvt_pk_bf16_f32 v164, v166, v167
    v_mfma_f32_16x16x32_bf16 v[80:83], v[160:163], v[32:35], v[80:83]
    buffer_load_dwordx4 v149, s[16:19], s46 offen offset:1024 lds
    v_mfma_f32_16x16x32_bf16 v[96:99], a[148:151], v[240:243], v[96:99]
    s_xor_b32 s46, s41, 1
    s_mul_i32 s46, s46, 229376
    s_add_u32 s46, s46, s45
    v_mfma_f32_16x16x32_bf16 v[96:99], a[164:167], v[244:247], v[96:99]
    s_add_u32 s46, s46, 30720
    v_mul_f32 v80, v80, |v80|
    v_mul_f32 v81, v81, |v81|
    v_mfma_f32_16x16x32_bf16 v[96:99], a[180:183], v[200:203], v[96:99]
    s_xor_b32 s46, s46, 512
    v_mul_f32 v82, v82, |v82|
    v_mul_f32 v83, v83, |v83|
    v_mfma_f32_16x16x32_bf16 v[96:99], a[196:199], v[204:207], v[96:99]
    s_waitcnt lgkmcnt(0)
    v_cvt_pk_bf16_f32 v80, v80, v81
    v_cvt_pk_bf16_f32 v81, v82, v83
    v_mfma_f32_16x16x32_bf16 v[96:99], a[212:215], v[56:59], v[96:99]
    buffer_load_dwordx4 v148, s[16:19], s46 offen offset:2048 lds
    v_mfma_f32_16x16x32_bf16 v[96:99], a[228:231], v[60:63], v[96:99]
    v_pk_max_i16 v80, v80, 0
    v_pk_max_i16 v81, v81, 0
    v_lshlrev_b32 v167, 16, v164
    v_sub_f32 v166, v166, v167
    v_mov_b32 v165, v164
    v_cvt_pk_bf16_f32 v166, v166, 0
    v_mov_b32 v167, 0
    v_mfma_f32_16x16x32_bf16 v[96:99], a[244:247], v[232:235], v[96:99]
    buffer_load_dwordx4 v149, s[16:19], s46 offen offset:3072 lds
    v_mfma_f32_16x16x32_bf16 v[96:99], v[164:167], v[32:35], v[96:99]
    s_add_u32 m0, s1, 8192
    v_add_f32 v174, v170, v171
    v_add_f32 v170, v168, v169
    v_mfma_f32_16x16x32_bf16 v[84:87], a[240:243], v[236:239], v[84:87]
    s_xor_b32 s46, s41, 2
    v_lshlrev_b32 v171, 16, v26
    s_mul_i32 s46, s46, 229376
    v_mfma_f32_16x16x32_bf16 v[84:87], a[224:227], v[192:195], v[84:87]
    s_add_u32 s46, s46, s45
    v_mul_f32 v96, v96, |v96|
    v_mul_f32 v97, v97, |v97|
    v_mfma_f32_16x16x32_bf16 v[84:87], a[208:211], v[196:199], v[84:87]
    s_add_u32 s46, s46, 32768
    v_mul_f32 v98, v98, |v98|
    s_xor_b32 s46, s46, 512
    v_mfma_f32_16x16x32_bf16 v[84:87], a[192:195], v[216:219], v[84:87]
    buffer_load_dwordx4 v148, s[16:19], s46 offen offset:0 lds
    v_mfma_f32_16x16x32_bf16 v[84:87], a[176:179], v[220:223], v[84:87]
    v_mul_f32 v99, v99, |v99|
    v_cvt_pk_bf16_f32 v82, v96, v97
    v_mfma_f32_16x16x32_bf16 v[84:87], a[160:163], v[48:51], v[84:87]
    v_cvt_pk_bf16_f32 v83, v98, v99
    v_pk_max_i16 v82, v82, 0
    v_mfma_f32_16x16x32_bf16 v[84:87], a[144:147], v[52:55], v[84:87]
    buffer_load_dwordx4 v149, s[16:19], s46 offen offset:1024 lds
    v_mfma_f32_16x16x32_bf16 v[84:87], v[160:163], v[16:19], v[84:87]
    s_xor_b32 s46, s41, 3
    v_pk_max_i16 v83, v83, 0
    v_cvt_pk_bf16_f32 v168, v170, v171
    v_mfma_f32_16x16x32_bf16 v[100:103], a[244:247], v[236:239], v[100:103]
    buffer_store_dwordx4 v[80:83], v3, s[24:27], s52 offen offset:0 sc1
    v_mfma_f32_16x16x32_bf16 v[100:103], a[228:231], v[192:195], v[100:103]
    s_mul_i32 s46, s46, 229376
    v_mul_f32 v84, v84, |v84|
    v_mul_f32 v85, v85, |v85|
    v_mfma_f32_16x16x32_bf16 v[100:103], a[212:215], v[196:199], v[100:103]
    s_add_u32 s46, s46, s45
    v_mul_f32 v86, v86, |v86|
    v_mul_f32 v87, v87, |v87|
    v_mfma_f32_16x16x32_bf16 v[100:103], a[196:199], v[216:219], v[100:103]
    s_add_u32 s46, s46, 30720
    v_cvt_pk_bf16_f32 v84, v84, v85
    v_cvt_pk_bf16_f32 v85, v86, v87
    v_mfma_f32_16x16x32_bf16 v[100:103], a[180:183], v[220:223], v[100:103]
    s_xor_b32 s46, s46, 512
    v_pk_max_i16 v84, v84, 0
    v_pk_max_i16 v85, v85, 0
    v_mfma_f32_16x16x32_bf16 v[100:103], a[164:167], v[48:51], v[100:103]
    buffer_load_dwordx4 v148, s[16:19], s46 offen offset:2048 lds
    v_mfma_f32_16x16x32_bf16 v[100:103], a[148:151], v[52:55], v[100:103]
    ds_read_b128 v[136:139], v9 offset:12288
    v_lshlrev_b32 v171, 16, v168
    v_mfma_f32_16x16x32_bf16 v[100:103], v[164:167], v[16:19], v[100:103]
    buffer_load_dwordx4 v149, s[16:19], s46 offen offset:3072 lds
    v_mfma_f32_16x16x32_bf16 v[88:91], a[144:147], v[248:251], v[88:91]
    v_sub_f32 v170, v170, v171
    v_mov_b32 v169, v168
    v_mfma_f32_16x16x32_bf16 v[88:91], a[160:163], v[252:255], v[88:91]
    v_mul_f32 v100, v100, |v100|
    v_mul_f32 v101, v101, |v101|
    v_mfma_f32_16x16x32_bf16 v[88:91], a[176:179], v[72:75], v[88:91]
    v_mul_f32 v102, v102, |v102|
    v_mul_f32 v103, v103, |v103|
    v_mfma_f32_16x16x32_bf16 v[88:91], a[192:195], v[76:79], v[88:91]
    v_cvt_pk_bf16_f32 v86, v100, v101
    v_cvt_pk_bf16_f32 v87, v102, v103
    v_mfma_f32_16x16x32_bf16 v[88:91], a[208:211], v[224:227], v[88:91]
    s_waitcnt lgkmcnt(0)
    v_pk_max_i16 v86, v86, 0
    v_pk_max_i16 v87, v87, 0
    v_mfma_f32_16x16x32_bf16 v[88:91], a[224:227], v[228:231], v[88:91]
    buffer_store_dwordx4 v[84:87], v3, s[24:27], s52 offen offset:1024 sc1
    v_mfma_f32_16x16x32_bf16 v[88:91], a[240:243], v[136:139], v[88:91]
    ds_read_b128 v[140:143], v9 offset:13312
    v_cvt_pk_bf16_f32 v170, v170, 0
    v_mfma_f32_16x16x32_bf16 v[88:91], v[160:163], v[36:39], v[88:91]
    ds_read_b128 v[208:211], v9 offset:5120
    v_mov_b32 v171, 0
    v_mfma_f32_16x16x32_bf16 v[104:107], a[148:151], v[248:251], v[104:107]
    v_lshlrev_b32 v175, 16, v27
    v_cvt_pk_bf16_f32 v172, v174, v175
    v_mfma_f32_16x16x32_bf16 v[104:107], a[164:167], v[252:255], v[104:107]
    v_lshlrev_b32 v175, 16, v172
    v_sub_f32 v174, v174, v175
    v_mfma_f32_16x16x32_bf16 v[104:107], a[180:183], v[72:75], v[104:107]
    v_mov_b32 v173, v172
    v_mul_f32 v88, v88, |v88|
    v_mfma_f32_16x16x32_bf16 v[104:107], a[196:199], v[76:79], v[104:107]
    v_mul_f32 v89, v89, |v89|
    v_mul_f32 v90, v90, |v90|
    v_mfma_f32_16x16x32_bf16 v[104:107], a[212:215], v[224:227], v[104:107]
    v_mul_f32 v91, v91, |v91|
    v_cvt_pk_bf16_f32 v88, v88, v89
    v_mfma_f32_16x16x32_bf16 v[104:107], a[228:231], v[228:231], v[104:107]
    v_cvt_pk_bf16_f32 v89, v90, v91
    v_pk_max_i16 v88, v88, 0
    v_mfma_f32_16x16x32_bf16 v[104:107], a[244:247], v[136:139], v[104:107]
    v_pk_max_i16 v89, v89, 0
    v_cvt_pk_bf16_f32 v174, v174, 0
    v_mfma_f32_16x16x32_bf16 v[104:107], v[164:167], v[36:39], v[104:107]
    v_mov_b32 v175, 0
    v_xor_b32 v9, 16384, v9
    v_mfma_f32_16x16x32_bf16 v[112:115], a[152:155], v[240:243], v[112:115]
    ds_read_b128 v[212:215], v9 offset:13312
    ds_read_b128 v[64:67], v9 offset:5120
    v_mfma_f32_16x16x32_bf16 v[112:115], a[168:171], v[244:247], v[112:115]
    v_xor_b32 v9, 49152, v9
    v_mul_f32 v104, v104, |v104|
    v_mfma_f32_16x16x32_bf16 v[112:115], a[184:187], v[200:203], v[112:115]
    ds_read_b128 v[68:71], v9 offset:13312
    v_mul_f32 v105, v105, |v105|
    v_mfma_f32_16x16x32_bf16 v[112:115], a[200:203], v[204:207], v[112:115]
    v_mul_f32 v106, v106, |v106|
    v_mul_f32 v107, v107, |v107|
    v_mfma_f32_16x16x32_bf16 v[112:115], a[216:219], v[56:59], v[112:115]
    v_cvt_pk_bf16_f32 v90, v104, v105
    v_cvt_pk_bf16_f32 v91, v106, v107
    v_mfma_f32_16x16x32_bf16 v[112:115], a[232:235], v[60:63], v[112:115]
    v_pk_max_i16 v90, v90, 0
    v_pk_max_i16 v91, v91, 0
    v_mfma_f32_16x16x32_bf16 v[112:115], a[248:251], v[232:235], v[112:115]
    buffer_store_dwordx4 v[88:91], v3, s[24:27], s52 offen offset:2048 sc1
    v_mfma_f32_16x16x32_bf16 v[112:115], v[168:171], v[32:35], v[112:115]
    s_waitcnt vmcnt(19)
    ds_read_b128 v[96:99], v9 offset:5120
    v_xor_b32 v9, 16384, v9
    v_mfma_f32_16x16x32_bf16 v[116:119], a[248:251], v[236:239], v[116:119]
    ds_read_b128 v[100:103], v9 offset:13312
    ds_read_b64_tr_b16 a[32:33], v152 offset:12288
    v_mfma_f32_16x16x32_bf16 v[116:119], a[232:235], v[192:195], v[116:119]
    ds_read_b64_tr_b16 a[34:35], v152 offset:14336
    v_mul_f32 v112, v112, |v112|
    v_mfma_f32_16x16x32_bf16 v[116:119], a[216:219], v[196:199], v[116:119]
    ds_read_b64_tr_b16 a[36:37], v153 offset:12288
    ds_read_b64_tr_b16 a[38:39], v153 offset:14336
    v_mfma_f32_16x16x32_bf16 v[116:119], a[200:203], v[216:219], v[116:119]
    ds_read_b64_tr_b16 a[40:41], v154 offset:12288
    ds_read_b64_tr_b16 a[42:43], v154 offset:14336
    v_mfma_f32_16x16x32_bf16 v[116:119], a[184:187], v[220:223], v[116:119]
    ds_read_b64_tr_b16 a[44:45], v155 offset:12288
    ds_read_b64_tr_b16 a[46:47], v155 offset:14336
    v_mfma_f32_16x16x32_bf16 v[116:119], a[168:171], v[48:51], v[116:119]
    v_mul_f32 v113, v113, |v113|
    v_mul_f32 v114, v114, |v114|
    v_mfma_f32_16x16x32_bf16 v[116:119], a[152:155], v[52:55], v[116:119]
    s_waitcnt vmcnt(15)
    ds_read_b64_tr_b16 a[48:49], v152 offset:16384
    v_mul_f32 v115, v115, |v115|
    v_mfma_f32_16x16x32_bf16 v[116:119], v[168:171], v[16:19], v[116:119]
    s_add_u32 s53, s52, 4096
    v_cvt_pk_bf16_f32 v112, v112, v113
    v_cvt_pk_bf16_f32 v113, v114, v115
    v_mfma_f32_16x16x32_bf16 v[128:131], a[156:159], v[240:243], v[128:131]
    v_pk_max_i16 v112, v112, 0
    v_pk_max_i16 v113, v113, 0
    v_mfma_f32_16x16x32_bf16 v[128:131], a[172:175], v[244:247], v[128:131]
    v_mul_f32 v116, v116, |v116|
    v_mul_f32 v117, v117, |v117|
    v_mfma_f32_16x16x32_bf16 v[128:131], a[188:191], v[200:203], v[128:131]
    v_mul_f32 v118, v118, |v118|
    v_mul_f32 v119, v119, |v119|
    v_mfma_f32_16x16x32_bf16 v[128:131], a[204:207], v[204:207], v[128:131]
    v_cvt_pk_bf16_f32 v114, v116, v117
    v_cvt_pk_bf16_f32 v115, v118, v119
    v_mfma_f32_16x16x32_bf16 v[128:131], a[220:223], v[56:59], v[128:131]
    v_pk_max_i16 v114, v114, 0
    v_pk_max_i16 v115, v115, 0
    v_mfma_f32_16x16x32_bf16 v[128:131], a[236:239], v[60:63], v[128:131]
    buffer_store_dwordx4 v[112:115], v3, s[24:27], s53 offen offset:0 sc1
    v_mfma_f32_16x16x32_bf16 v[128:131], a[252:255], v[232:235], v[128:131]
    s_waitcnt vmcnt(12)
    ds_read_b64_tr_b16 a[50:51], v152 offset:18432
    ds_read_b64_tr_b16 a[52:53], v153 offset:16384
    v_mfma_f32_16x16x32_bf16 v[128:131], v[172:175], v[32:35], v[128:131]
L_pad4:
    s_cbranch_execz L_retB
    ds_read_b64_tr_b16 a[54:55], v153 offset:18432
    ds_read_b64_tr_b16 a[56:57], v154 offset:16384
    v_mfma_f32_16x16x32_bf16 v[132:135], a[252:255], v[236:239], v[132:135]
    ds_read_b64_tr_b16 a[58:59], v154 offset:18432
    ds_read_b64_tr_b16 a[60:61], v155 offset:16384
    v_mfma_f32_16x16x32_bf16 v[132:135], a[236:239], v[192:195], v[132:135]
    ds_read_b64_tr_b16 a[62:63], v155 offset:18432
    ds_read_b64_tr_b16 a[64:65], v152 offset:0
    v_mfma_f32_16x16x32_bf16 v[132:135], a[220:223], v[196:199], v[132:135]
    ds_read_b64_tr_b16 a[66:67], v152 offset:2048
    ds_read_b64_tr_b16 a[68:69], v153 offset:0
    v_mfma_f32_16x16x32_bf16 v[132:135], a[204:207], v[216:219], v[132:135]
    ds_read_b64_tr_b16 a[70:71], v153 offset:2048
    ds_read_b64_tr_b16 a[72:73], v154 offset:0
    v_mfma_f32_16x16x32_bf16 v[132:135], a[188:191], v[220:223], v[132:135]
    ds_read_b64_tr_b16 a[74:75], v154 offset:2048
    ds_read_b64_tr_b16 a[76:77], v155 offset:0
    v_mfma_f32_16x16x32_bf16 v[132:135], a[172:175], v[48:51], v[132:135]
    v_mul_f32 v128, v128, |v128|
    v_mul_f32 v129, v129, |v129|
    v_mfma_f32_16x16x32_bf16 v[132:135], a[156:159], v[52:55], v[132:135]
    s_waitcnt vmcnt(8)
    v_mul_f32 v130, v130, |v130|
    v_mul_f32 v131, v131, |v131|
    v_mfma_f32_16x16x32_bf16 v[132:135], v[172:175], v[16:19], v[132:135]
    s_waitcnt lgkmcnt(10)
    v_cvt_pk_bf16_f32 v128, v128, v129
    v_cvt_pk_bf16_f32 v129, v130, v131
    v_mfma_f32_16x16x32_bf16 v[92:95], a[240:243], v[140:143], v[92:95]
    s_add_u32 s53, s52, 4096
    v_pk_max_i16 v128, v128, 0
    v_pk_max_i16 v129, v129, 0
    v_mfma_f32_16x16x32_bf16 v[92:95], a[224:227], v[208:211], v[92:95]
    v_mul_f32 v132, v132, |v132|
    v_mul_f32 v133, v133, |v133|
    v_mfma_f32_16x16x32_bf16 v[92:95], a[208:211], v[212:215], v[92:95]
    v_mul_f32 v134, v134, |v134|
    v_mul_f32 v135, v135, |v135|
    v_mfma_f32_16x16x32_bf16 v[92:95], a[192:195], v[64:67], v[92:95]
    v_cvt_pk_bf16_f32 v130, v132, v133
    v_cvt_pk_bf16_f32 v131, v134, v135
    v_mfma_f32_16x16x32_bf16 v[92:95], a[176:179], v[68:71], v[92:95]
    v_pk_max_i16 v130, v130, 0
    v_pk_max_i16 v131, v131, 0
    v_mfma_f32_16x16x32_bf16 v[92:95], a[160:163], v[96:99], v[92:95]
    buffer_store_dwordx4 v[128:131], v3, s[24:27], s53 offen offset:2048 sc1
    v_mfma_f32_16x16x32_bf16 v[92:95], a[144:147], v[100:103], v[92:95]
    s_waitcnt vmcnt(4)
    ds_read_b64_tr_b16 a[78:79], v155 offset:2048
    ds_read_b64_tr_b16 a[80:81], v152 offset:4096
    v_mfma_f32_16x16x32_bf16 v[92:95], v[160:163], v[20:23], v[92:95]
    ds_read_b64_tr_b16 a[82:83], v152 offset:6144
    ds_read_b64_tr_b16 a[84:85], v153 offset:4096
    v_mfma_f32_16x16x32_bf16 v[108:111], a[244:247], v[140:143], v[108:111]
    ds_read_b64_tr_b16 a[86:87], v153 offset:6144
    ds_read_b64_tr_b16 a[88:89], v154 offset:4096
    v_mfma_f32_16x16x32_bf16 v[108:111], a[228:231], v[208:211], v[108:111]
    ds_read_b64_tr_b16 a[90:91], v154 offset:6144
    ds_read_b64_tr_b16 a[92:93], v155 offset:4096
    v_mfma_f32_16x16x32_bf16 v[108:111], a[212:215], v[212:215], v[108:111]
    ds_read_b64_tr_b16 a[94:95], v155 offset:6144
    ds_read_b64_tr_b16 a[96:97], v152 offset:8192
    v_mfma_f32_16x16x32_bf16 v[108:111], a[196:199], v[64:67], v[108:111]
    ds_read_b64_tr_b16 a[98:99], v152 offset:10240
    ds_read_b64_tr_b16 a[100:101], v153 offset:8192
    v_mfma_f32_16x16x32_bf16 v[108:111], a[180:183], v[68:71], v[108:111]
    ds_read_b64_tr_b16 a[102:103], v153 offset:10240
    ds_read_b64_tr_b16 a[104:105], v154 offset:8192
    v_mfma_f32_16x16x32_bf16 v[108:111], a[164:167], v[96:99], v[108:111]
    v_mul_f32 v92, v92, |v92|
    v_mul_f32 v93, v93, |v93|
    v_mfma_f32_16x16x32_bf16 v[108:111], a[148:151], v[100:103], v[108:111]
    v_mul_f32 v94, v94, |v94|
    v_mul_f32 v95, v95, |v95|
    v_mfma_f32_16x16x32_bf16 v[108:111], v[164:167], v[20:23], v[108:111]
    v_cvt_pk_bf16_f32 v92, v92, v93
    v_cvt_pk_bf16_f32 v93, v94, v95
    v_mfma_f32_16x16x32_bf16 v[120:123], a[152:155], v[248:251], v[120:123]
    v_pk_max_i16 v92, v92, 0
    v_pk_max_i16 v93, v93, 0
    v_mfma_f32_16x16x32_bf16 v[120:123], a[168:171], v[252:255], v[120:123]
    v_mul_f32 v108, v108, |v108|
    v_mul_f32 v109, v109, |v109|
    v_mfma_f32_16x16x32_bf16 v[120:123], a[184:187], v[72:75], v[120:123]
    v_mul_f32 v110, v110, |v110|
    v_mul_f32 v111, v111, |v111|
    v_mfma_f32_16x16x32_bf16 v[120:123], a[200:203], v[76:79], v[120:123]
    v_cvt_pk_bf16_f32 v94, v108, v109
    v_cvt_pk_bf16_f32 v95, v110, v111
    v_mfma_f32_16x16x32_bf16 v[120:123], a[216:219], v[224:227], v[120:123]
    v_pk_max_i16 v94, v94, 0
    v_pk_max_i16 v95, v95, 0
    v_mfma_f32_16x16x32_bf16 v[120:123], a[232:235], v[228:231], v[120:123]
    buffer_store_dwordx4 v[92:95], v3, s[24:27], s52 offen offset:3072 sc1
    v_mfma_f32_16x16x32_bf16 v[120:123], a[248:251], v[136:139], v[120:123]
    ds_read_b64_tr_b16 a[106:107], v154 offset:10240
    ds_read_b64_tr_b16 a[108:109], v155 offset:8192
    v_mfma_f32_16x16x32_bf16 v[120:123], v[168:171], v[36:39], v[120:123]
    ds_read_b64_tr_b16 a[110:111], v155 offset:10240
    v_mfma_f32_16x16x32_bf16 v[124:127], a[248:251], v[140:143], v[124:127]
    v_mfma_f32_16x16x32_bf16 v[124:127], a[232:235], v[208:211], v[124:127]
    v_mul_f32 v120, v120, |v120|
    v_mul_f32 v121, v121, |v121|
    v_mfma_f32_16x16x32_bf16 v[124:127], a[216:219], v[212:215], v[124:127]
    v_mul_f32 v122, v122, |v122|
    v_mul_f32 v123, v123, |v123|
    v_mfma_f32_16x16x32_bf16 v[124:127], a[200:203], v[64:67], v[124:127]
    v_cvt_pk_bf16_f32 v120, v120, v121
    v_cvt_pk_bf16_f32 v121, v122, v123
    v_mfma_f32_16x16x32_bf16 v[124:127], a[184:187], v[68:71], v[124:127]
    v_pk_max_i16 v120, v120, 0
    v_pk_max_i16 v121, v121, 0
    v_mfma_f32_16x16x32_bf16 v[124:127], a[168:171], v[96:99], v[124:127]
    v_mfma_f32_16x16x32_bf16 v[124:127], a[152:155], v[100:103], v[124:127]
    v_mfma_f32_16x16x32_bf16 v[124:127], v[168:171], v[20:23], v[124:127]
    s_add_u32 s53, s52, 4096
    s_lshl2_add_u32 s5, s41, s3
    s_lshl_b32 s5, s5, 4
    v_mfma_f32_16x16x32_bf16 v[44:47], a[0:3], v[80:83], 0
    s_andn2_b32 s6, 4, s41
    s_xor_b32 s7, s3, 3
    s_lshl3_add_u32 s6, s7, s6
    v_mfma_f32_16x16x32_bf16 v[28:31], a[0:3], v[84:87], 0
    s_lshl_b32 s6, s6, 11
    v_mul_f32 v124, v124, |v124|
    v_mul_f32 v125, v125, |v125|
    v_mfma_f32_16x16x32_bf16 v[24:27], a[0:3], v[88:91], 0
    s_add_u32 m0, s1, 12288
    v_mul_f32 v126, v126, |v126|
    v_mul_f32 v127, v127, |v127|
    v_mfma_f32_16x16x32_bf16 v[104:107], a[0:3], v[92:95], 0
    s_lshl1_add_u32 s46, s43, 0
    v_cvt_pk_bf16_f32 v122, v124, v125
    v_cvt_pk_bf16_f32 v123, v126, v127
    v_mfma_f32_16x16x32_bf16 v[240:243], a[4:7], v[80:83], 0
    s_xor_b32 s46, s46, s41
    v_pk_max_i16 v122, v122, 0
    v_pk_max_i16 v123, v123, 0
    v_mfma_f32_16x16x32_bf16 v[244:247], a[4:7], v[84:87], 0
    buffer_store_dwordx4 v[120:123], v3, s[24:27], s53 offen offset:1024 sc1
    v_mfma_f32_16x16x32_bf16 v[200:203], a[4:7], v[88:91], 0
    s_mul_i32 s46, s46, 229376
    v_lshl_add_u32 v6, v2, 2, s5
    v_lshlrev_b32 v184, 1, v6
    v_mfma_f32_16x16x32_bf16 v[204:207], a[4:7], v[92:95], 0
    buffer_load_dwordx2 v[182:183], v184, s[32:35], 0 offen
    v_mfma_f32_16x16x32_bf16 v[56:59], a[8:11], v[80:83], 0
    s_add_u32 s46, s46, s45
    s_lshl_b32 s55, s43, 16
    s_sub_u32 s46, s46, s55
    v_mfma_f32_16x16x32_bf16 v[116:119], a[8:11], v[84:87], 0
    s_add_u32 s46, s46, 49152
    s_xor_b32 s46, s46, 512
    v_and_b32 v9, 7, v0
    v_mfma_f32_16x16x32_bf16 v[60:63], a[8:11], v[88:91], 0
    buffer_load_dwordx4 v148, s[16:19], s46 offen offset:0 lds
    v_mfma_f32_16x16x32_bf16 v[232:235], a[8:11], v[92:95], 0
    s_and_b32 s7, s41, 4
    v_lshlrev_b32 v9, 3, v9
    v_add_u32 v8, s6, v3
    v_mfma_f32_16x16x32_bf16 v[32:35], a[12:15], v[80:83], 0
    s_add_u32 s6, s7, s43
    s_lshl_b32 s6, s6, 11
    s_cmp_ge_u32 s41, 4
    v_mfma_f32_16x16x32_bf16 v[236:239], a[12:15], v[84:87], 0
    buffer_load_dwordx4 v149, s[16:19], s46 offen offset:1024 lds
    v_mfma_f32_16x16x32_bf16 v[192:195], a[12:15], v[88:91], 0
    s_cselect_b64 vcc, -1, 0
    s_lshl1_add_u32 s46, s43, 1
    s_xor_b32 s46, s46, s41
    v_mfma_f32_16x16x32_bf16 v[196:199], a[12:15], v[92:95], 0
    s_mul_i32 s46, s46, 229376
    s_add_u32 s46, s46, s45
    s_lshl_b32 s55, s43, 16
    v_mfma_f32_16x16x32_bf16 v[216:219], a[16:19], v[80:83], 0
    s_sub_u32 s46, s46, s55
    v_lshl_add_u32 v163, v1, 4, s6
    v_sub_u32 v185, 512, v6
    v_mfma_f32_16x16x32_bf16 v[220:223], a[16:19], v[84:87], 0
    s_add_u32 s46, s46, 47104
    v_cndmask_b32 v185, v6, v185, vcc
    v_subrev_u32 v186, s7, v185
    v_mfma_f32_16x16x32_bf16 v[48:51], a[16:19], v[88:91], 0
    s_xor_b32 s46, s46, 512
    v_and_b32 v7, 0xc0, v185
    v_lshl_add_u32 v160, v7, 8, v163
    v_mfma_f32_16x16x32_bf16 v[52:55], a[16:19], v[92:95], 0
    buffer_load_dwordx4 v148, s[16:19], s46 offen offset:2048 lds
    v_mfma_f32_16x16x32_bf16 v[16:19], a[20:23], v[80:83], 0
    s_waitcnt lgkmcnt(15)
    v_and_b32 v7, 0x20, v185
    v_lshl_add_u32 v160, v7, 7, v160
    v_mfma_f32_16x16x32_bf16 v[132:135], a[20:23], v[84:87], 0
    buffer_load_dwordx4 v149, s[16:19], s46 offen offset:3072 lds
    v_mfma_f32_16x16x32_bf16 v[128:131], a[20:23], v[88:91], 0
    s_add_u32 m0, s1, 16384
    v_and_b32 v7, 0x18, v185
    v_lshl_add_u32 v160, v7, 5, v160
    v_mfma_f32_16x16x32_bf16 v[248:251], a[20:23], v[92:95], 0
    s_xor_b32 s46, s41, 1
    v_and_b32 v7, 7, v185
    v_lshl_add_u32 v160, v7, 1, v160
    v_mfma_f32_16x16x32_bf16 v[252:255], a[24:27], v[80:83], 0
    s_mul_i32 s46, s46, 229376
    v_and_b32 v7, 0xc0, v186
    v_lshl_add_u32 v162, v7, 8, v163
    v_mfma_f32_16x16x32_bf16 v[72:75], a[24:27], v[84:87], 0
    s_add_u32 s46, s46, s45
    v_and_b32 v7, 0x20, v186
    v_lshl_add_u32 v162, v7, 7, v162
    v_mfma_f32_16x16x32_bf16 v[76:79], a[24:27], v[88:91], 0
    buffer_load_dwordx4 v148, s[16:19], s46 offen offset:0 lds
    v_mfma_f32_16x16x32_bf16 v[224:227], a[24:27], v[92:95], 0
    s_add_u32 s6, s7, 2
    v_and_b32 v7, 0x18, v186
    v_lshl_add_u32 v162, v7, 5, v162
    v_and_b32 v7, 7, v186
    v_lshl_add_u32 v162, v7, 1, v162
    v_mfma_f32_16x16x32_bf16 v[108:111], a[28:31], v[80:83], 0
    s_lshl_b32 s5, s5, 1
    v_add_u32 v161, s6, v162
    v_xor_b32 v163, 4, v161
    v_add_u32 v162, 4, v162
    v_lshrrev_b32 v6, 5, v0
    v_lshlrev_b32 v6, 4, v6
    v_add_u32 v6, s5, v6
    v_sub_u32 v7, 2048, v190
    v_cmp_eq_u32 vcc, 0, v190
    v_mfma_f32_16x16x32_bf16 v[228:231], a[28:31], v[84:87], 0
    s_cmp_eq_u32 s43, 1
    v_mov_b32 v164, 1024
    v_cndmask_b32 v7, v7, v164, vcc
    v_mfma_f32_16x16x32_bf16 v[136:139], a[28:31], v[88:91], 0
    s_cselect_b64 vcc, -1, 0
    s_and_b32 s4, s41, 3
    s_lshl1_add_u32 s4, s4, s43
    buffer_load_dwordx4 v149, s[16:19], s46 offen offset:1024 lds
    v_cndmask_b32 v164, v190, v7, vcc
    v_mfma_f32_16x16x32_bf16 v[36:39], a[28:31], v[92:95], 0
    s_lshl3_add_u32 s4, s4, s101
    v_cndmask_b32 v165, v7, v190, vcc
    v_lshl_add_u32 v164, v164, 10, v6
    v_lshl_add_u32 v165, v165, 10, v6
    s_mov_b64 exec, 1
    s_cmp_eq_u32 s37, 0
    s_waitcnt vmcnt(7)
    s_cbranch_scc1 L_slow_6
    buffer_store_dwordx2 v[4:5], off, s[24:27], s4
    s_branch L_dj_7
L_slow_6:
    buffer_store_dwordx2 v[4:5], off, s[24:27], s4 sc1
L_dj_7:
    s_mov_b64 exec, -1
    s_barrier
    s_waitcnt lgkmcnt(8)
    s_waitcnt lgkmcnt(0)
    s_add_u32 s46, s46, 14336
    buffer_load_dwordx4 v148, s[16:19], s46 offen offset:2048 lds
    buffer_load_dwordx4 v149, s[16:19], s46 offen offset:3072 lds
    s_add_u32 m0, s1, 0
    s_xor_b32 s46, s41, 2
    s_mul_i32 s46, s46, 229376
    s_add_u32 s46, s46, s45
    buffer_load_dwordx4 v148, s[16:19], s46 offen offset:0 lds
    buffer_load_dwordx4 v149, s[16:19], s46 offen offset:1024 lds
    s_add_u32 s46, s46, 14336
    buffer_load_dwordx4 v148, s[16:19], s46 offen offset:2048 lds
    buffer_load_dwordx4 v149, s[16:19], s46 offen offset:3072 lds
    s_add_u32 m0, s1, 4096
    s_xor_b32 s46, s41, 3
    s_mul_i32 s46, s46, 229376
    s_add_u32 s46, s46, s45
    buffer_load_dwordx4 v148, s[16:19], s46 offen offset:0 lds
    buffer_load_dwordx4 v149, s[16:19], s46 offen offset:1024 lds
    s_add_u32 s46, s46, 14336
    buffer_load_dwordx4 v148, s[16:19], s46 offen offset:2048 lds
    buffer_load_dwordx4 v149, s[16:19], s46 offen offset:3072 lds
    s_add_u32 m0, s1, 8192
    s_mul_i32 s46, s41, 229376
    s_add_u32 s46, s46, s45
    s_add_u32 s46, s46, 32768
    buffer_load_dwordx2 v[144:145], v9, s[24:27], s101 offen sc1
    buffer_load_dwordx4 v148, s[16:19], s46 offen offset:0 lds
    buffer_load_dwordx4 v149, s[16:19], s46 offen offset:1024 lds
    s_xor_b32 s46, s41, 1
    s_mul_i32 s46, s46, 229376
    s_add_u32 s46, s46, s45
    s_add_u32 s46, s46, 30720
    buffer_load_dwordx4 v148, s[16:19], s46 offen offset:2048 lds
    buffer_load_dwordx4 v149, s[16:19], s46 offen offset:3072 lds
    s_waitcnt vmcnt(18)
    ds_read_b64_tr_b16 a[112:113], v152 offset:12288
    s_add_u32 m0, s1, 12288
    ds_read_b64_tr_b16 a[114:115], v152 offset:14336
    s_xor_b32 s46, s41, 2
    ds_read_b64_tr_b16 a[116:117], v153 offset:12288
    s_mul_i32 s46, s46, 229376
    ds_read_b64_tr_b16 a[118:119], v153 offset:14336
    s_add_u32 s46, s46, s45
    ds_read_b64_tr_b16 a[120:121], v154 offset:12288
    s_add_u32 s46, s46, 32768
    ds_read_b64_tr_b16 a[122:123], v154 offset:14336
    ds_read_b64_tr_b16 a[124:125], v155 offset:12288
    ds_read_b64_tr_b16 a[126:127], v155 offset:14336
    s_waitcnt lgkmcnt(0)
    buffer_load_dwordx4 v148, s[16:19], s46 offen offset:0 lds
    buffer_load_dwordx4 v149, s[16:19], s46 offen offset:1024 lds
    s_xor_b32 s46, s41, 3
    s_mul_i32 s46, s46, 229376
    s_add_u32 s46, s46, s45
    s_add_u32 s46, s46, 30720
    buffer_load_dwordx4 v148, s[16:19], s46 offen offset:2048 lds
    buffer_load_dwordx4 v149, s[16:19], s46 offen offset:3072 lds
    s_waitcnt vmcnt(8)
    v_cmp_ne_u64 vcc, v[144:145], v[4:5]
    s_mov_b32 s36, 0x20000
    s_cbranch_vccz L_polld_9
L_poll_8:
    buffer_load_dwordx2 v[144:145], v9, s[24:27], s101 offen sc1
    s_sub_u32 s36, s36, 1
    s_cbranch_scc1 L_polld_9
    s_waitcnt vmcnt(0)
    v_cmp_ne_u64 vcc, v[144:145], v[4:5]
    s_cbranch_vccnz L_poll_8
L_polld_9:
    s_xor_b32 s53, s52, 65536
    buffer_load_dwordx4 a[224:227], v3, s[24:27], s53 offen offset:0 sc1
    buffer_load_dwordx4 a[228:231], v3, s[24:27], s53 offen offset:1024 sc1
    buffer_load_dwordx4 a[232:235], v3, s[24:27], s53 offen offset:2048 sc1
    buffer_load_dwordx4 a[236:239], v3, s[24:27], s53 offen offset:3072 sc1
    v_mov_b32 v157, 0x3f80
    v_cndmask_b32 v157, v157, 1.0, s[48:49]
    v_mov_b32 v191, 0x44444444
    v_mov_b32 v10, 0x4444eeee
    s_xor_b32 s53, s52, 131072
    s_mov_b32 vcc_lo, 0x0f00000f
    s_mov_b32 vcc_hi, 0x0f00000f
    v_cndmask_b32 v156, 0, v157, vcc
    v_cndmask_b32 v11, 0, v157, vcc
    s_mov_b32 vcc_lo, 0xf00000f0
    s_mov_b32 vcc_hi, 0xf00000f0
    v_cndmask_b32 v191, v191, v10, s[50:51]
    v_cndmask_b32 v158, 0, v157, vcc
    v_cndmask_b32 v13, 0, v157, vcc
    s_mov_b32 vcc_lo, 0x33333333
    s_mov_b32 vcc_hi, 0xcccccccc
    buffer_load_dwordx4 a[240:243], v3, s[24:27], s53 offen offset:0 sc1
    buffer_load_dwordx4 a[244:247], v3, s[24:27], s53 offen offset:1024 sc1
    buffer_load_dwordx4 a[248:251], v3, s[24:27], s53 offen offset:2048 sc1
    buffer_load_dwordx4 a[252:255], v3, s[24:27], s53 offen offset:3072 sc1
    v_mov_b32 v157, 0
    v_mov_b32 v159, 0
    v_mov_b32 v10, 0
    v_mov_b32 v12, 0
    v_cndmask_b32 v145, 0, v156, vcc
    v_cndmask_b32 v147, 0, v158, vcc
    v_mov_b32 v144, 0
    v_mov_b32 v146, 0
    s_xor_b32 s53, s52, 196608
    s_waitcnt vmcnt(7)
    v_mfma_f32_16x16x32_bf16 v[44:47], a[32:35], a[224:227], v[44:47]
    buffer_load_dwordx4 a[0:3], v3, s[24:27], s53 offen offset:0 sc1
    v_mfma_f32_16x16x32_bf16 v[240:243], a[36:39], a[224:227], v[240:243]
    buffer_load_dwordx4 a[4:7], v3, s[24:27], s53 offen offset:1024 sc1
    v_mfma_f32_16x16x32_bf16 v[56:59], a[40:43], a[224:227], v[56:59]
    buffer_load_dwordx4 a[8:11], v3, s[24:27], s53 offen offset:2048 sc1
    v_mfma_f32_16x16x32_bf16 v[32:35], a[44:47], a[224:227], v[32:35]
    buffer_load_dwordx4 a[12:15], v3, s[24:27], s53 offen offset:3072 sc1
    s_waitcnt vmcnt(10)
    v_mfma_f32_16x16x32_bf16 v[28:31], a[32:35], a[228:231], v[28:31]
    s_xor_b32 s53, s52, 69632
    v_mfma_f32_16x16x32_bf16 v[244:247], a[36:39], a[228:231], v[244:247]
    v_mfma_f32_16x16x32_bf16 v[116:119], a[40:43], a[228:231], v[116:119]
    v_mfma_f32_16x16x32_bf16 v[236:239], a[44:47], a[228:231], v[236:239]
    s_waitcnt vmcnt(9)
    v_mfma_f32_16x16x32_bf16 v[24:27], a[32:35], a[232:235], v[24:27]
    buffer_load_dwordx4 v[140:143], v3, s[24:27], s53 offen offset:0 sc1
    v_mfma_f32_16x16x32_bf16 v[200:203], a[36:39], a[232:235], v[200:203]
    buffer_load_dwordx4 v[208:211], v3, s[24:27], s53 offen offset:1024 sc1
    v_mfma_f32_16x16x32_bf16 v[60:63], a[40:43], a[232:235], v[60:63]
    s_xor_b32 s53, s52, 135168
    v_mfma_f32_16x16x32_bf16 v[192:195], a[44:47], a[232:235], v[192:195]
    s_waitcnt vmcnt(10)
    v_mfma_f32_16x16x32_bf16 v[104:107], a[32:35], a[236:239], v[104:107]
    v_mfma_f32_16x16x32_bf16 v[204:207], a[36:39], a[236:239], v[204:207]
    v_mfma_f32_16x16x32_bf16 v[232:235], a[40:43], a[236:239], v[232:235]
    v_mfma_f32_16x16x32_bf16 v[196:199], a[44:47], a[236:239], v[196:199]
    s_waitcnt vmcnt(9)
    v_mfma_f32_16x16x32_bf16 v[44:47], a[48:51], a[240:243], v[44:47]
    buffer_load_dwordx4 v[212:215], v3, s[24:27], s53 offen offset:0 sc1
    v_mfma_f32_16x16x32_bf16 v[240:243], a[52:55], a[240:243], v[240:243]
    s_xor_b32 s53, s52, 200704
    buffer_load_dwordx4 v[64:67], v3, s[24:27], s53 offen offset:0 sc1
    v_mfma_f32_16x16x32_bf16 v[56:59], a[56:59], a[240:243], v[56:59]
    s_xor_b32 s53, s52, 135168
    buffer_load_dwordx4 v[68:71], v3, s[24:27], s53 offen offset:1024 sc1
    v_mfma_f32_16x16x32_bf16 v[32:35], a[60:63], a[240:243], v[32:35]
    s_xor_b32 s53, s52, 200704
    buffer_load_dwordx4 v[96:99], v3, s[24:27], s53 offen offset:1024 sc1
    s_waitcnt vmcnt(12)
    v_mfma_f32_16x16x32_bf16 v[28:31], a[48:51], a[244:247], v[28:31]
    s_lshl_b32 s4, s43, 17
    s_xor_b32 s4, s4, s52
    s_xor_b32 s53, s4, 4096
    v_mfma_f32_16x16x32_bf16 v[244:247], a[52:55], a[244:247], v[244:247]
    v_mfma_f32_16x16x32_bf16 v[116:119], a[56:59], a[244:247], v[116:119]
    v_mfma_f32_16x16x32_bf16 v[236:239], a[60:63], a[244:247], v[236:239]
    s_waitcnt vmcnt(11)
    v_mfma_f32_16x16x32_bf16 v[24:27], a[48:51], a[248:251], v[24:27]
    buffer_load_dwordx4 v[100:103], v3, s[24:27], s53 offen offset:2048 sc1
    v_mfma_f32_16x16x32_bf16 v[200:203], a[52:55], a[248:251], v[200:203]
    s_xor_b32 s53, s4, 69632
    buffer_load_dwordx4 v[20:23], v3, s[24:27], s53 offen offset:2048 sc1
    v_mfma_f32_16x16x32_bf16 v[60:63], a[56:59], a[248:251], v[60:63]
    s_xor_b32 s53, s4, 20480
    buffer_load_dwordx4 v[168:171], v3, s[24:27], s53 offen offset:2048 sc1
    v_mfma_f32_16x16x32_bf16 v[192:195], a[60:63], a[248:251], v[192:195]
    s_xor_b32 s53, s4, 86016
    buffer_load_dwordx4 v[172:175], v3, s[24:27], s53 offen offset:2048 sc1
    s_waitcnt vmcnt(14)
    v_mfma_f32_16x16x32_bf16 v[104:107], a[48:51], a[252:255], v[104:107]
    v_mfma_f32_16x16x32_bf16 v[204:207], a[52:55], a[252:255], v[204:207]
    v_mfma_f32_16x16x32_bf16 v[232:235], a[56:59], a[252:255], v[232:235]
    v_mfma_f32_16x16x32_bf16 v[196:199], a[60:63], a[252:255], v[196:199]
    s_waitcnt vmcnt(13)
    v_mfma_f32_16x16x32_bf16 v[44:47], a[64:67], a[0:3], v[44:47]
    v_mfma_f32_16x16x32_bf16 v[240:243], a[68:71], a[0:3], v[240:243]
    v_mfma_f32_16x16x32_bf16 v[56:59], a[72:75], a[0:3], v[56:59]
    v_mfma_f32_16x16x32_bf16 v[32:35], a[76:79], a[0:3], v[32:35]
    s_waitcnt vmcnt(12)
    ds_read_b64_tr_b16 a[128:129], v152 offset:16384
    ds_read_b64_tr_b16 a[130:131], v152 offset:18432
    v_mfma_f32_16x16x32_bf16 v[28:31], a[64:67], a[4:7], v[28:31]
    ds_read_b64_tr_b16 a[132:133], v153 offset:16384
    ds_read_b64_tr_b16 a[134:135], v153 offset:18432
    v_mfma_f32_16x16x32_bf16 v[244:247], a[68:71], a[4:7], v[244:247]
    ds_read_b64_tr_b16 a[136:137], v154 offset:16384
    ds_read_b64_tr_b16 a[138:139], v154 offset:18432
    v_mfma_f32_16x16x32_bf16 v[116:119], a[72:75], a[4:7], v[116:119]
    ds_read_b64_tr_b16 a[140:141], v155 offset:16384
    v_mfma_f32_16x16x32_bf16 v[236:239], a[76:79], a[4:7], v[236:239]
    s_waitcnt vmcnt(11)
    ds_read_b64_tr_b16 a[142:143], v155 offset:18432
    ds_read_b64_tr_b16 a[144:145], v152 offset:0
    v_mfma_f32_16x16x32_bf16 v[24:27], a[64:67], a[8:11], v[24:27]
    ds_read_b64_tr_b16 a[146:147], v152 offset:2048
    ds_read_b64_tr_b16 a[148:149], v153 offset:0
    v_mfma_f32_16x16x32_bf16 v[200:203], a[68:71], a[8:11], v[200:203]
    ds_read_b64_tr_b16 a[150:151], v153 offset:2048
    ds_read_b64_tr_b16 a[152:153], v154 offset:0
    v_mfma_f32_16x16x32_bf16 v[60:63], a[72:75], a[8:11], v[60:63]
    ds_read_b64_tr_b16 a[154:155], v154 offset:2048
    ds_read_b64_tr_b16 a[156:157], v155 offset:0
    v_mfma_f32_16x16x32_bf16 v[192:195], a[76:79], a[8:11], v[192:195]
    s_waitcnt vmcnt(10)
    ds_read_b64_tr_b16 a[158:159], v155 offset:2048
    ds_read_b64_tr_b16 a[160:161], v152 offset:4096
    v_mfma_f32_16x16x32_bf16 v[104:107], a[64:67], a[12:15], v[104:107]
    ds_read_b64_tr_b16 a[162:163], v152 offset:6144
    ds_read_b64_tr_b16 a[164:165], v153 offset:4096
    v_mfma_f32_16x16x32_bf16 v[204:207], a[68:71], a[12:15], v[204:207]
    ds_read_b64_tr_b16 a[166:167], v153 offset:6144
    ds_read_b64_tr_b16 a[168:169], v154 offset:4096
    v_mfma_f32_16x16x32_bf16 v[232:235], a[72:75], a[12:15], v[232:235]
    ds_read_b64_tr_b16 a[170:171], v154 offset:6144
    ds_read_b64_tr_b16 a[172:173], v155 offset:4096
    v_mfma_f32_16x16x32_bf16 v[196:199], a[76:79], a[12:15], v[196:199]
    s_waitcnt vmcnt(9)
    v_swap_b32 v114, v140
    v_swap_b32 v115, v141
    s_nop 1
    v_mfma_f32_16x16x32_bf16 v[44:47], a[80:83], v[112:115], v[44:47]
    ds_read_b64_tr_b16 a[174:175], v155 offset:6144
    ds_read_b64_tr_b16 a[176:177], v152 offset:8192
    v_mfma_f32_16x16x32_bf16 v[28:31], a[80:83], v[140:143], v[28:31]
    s_waitcnt vmcnt(8)
    v_swap_b32 v122, v208
    v_swap_b32 v123, v209
    s_nop 1
    v_mfma_f32_16x16x32_bf16 v[24:27], a[80:83], v[120:123], v[24:27]
    ds_read_b64_tr_b16 a[178:179], v152 offset:10240
    ds_read_b64_tr_b16 a[180:181], v153 offset:8192
    v_mfma_f32_16x16x32_bf16 v[104:107], a[80:83], v[208:211], v[104:107]
    s_waitcnt vmcnt(6)
    v_swap_b32 v214, v64
    v_swap_b32 v215, v65
    s_nop 1
    v_mfma_f32_16x16x32_bf16 v[44:47], a[96:99], v[212:215], v[44:47]
    ds_read_b64_tr_b16 a[182:183], v153 offset:10240
    ds_read_b64_tr_b16 a[184:185], v154 offset:8192
    v_mfma_f32_16x16x32_bf16 v[28:31], a[96:99], v[64:67], v[28:31]
    s_waitcnt vmcnt(4)
    v_swap_b32 v70, v96
    v_swap_b32 v71, v97
    s_nop 1
    v_mfma_f32_16x16x32_bf16 v[24:27], a[96:99], v[68:71], v[24:27]
    ds_read_b64_tr_b16 a[186:187], v154 offset:10240
    ds_read_b64_tr_b16 a[188:189], v155 offset:8192
    v_mfma_f32_16x16x32_bf16 v[104:107], a[96:99], v[96:99], v[104:107]
    s_waitcnt vmcnt(2)
    v_swap_b32 v102, v20
    v_swap_b32 v103, v21
    s_nop 1
    v_mfma_f32_16x16x32_bf16 v[44:47], a[112:115], v[100:103], v[44:47]
    ds_read_b64_tr_b16 a[190:191], v155 offset:10240
    ds_read_b64_tr_b16 a[192:193], v152 offset:12288
    v_mfma_f32_16x16x32_bf16 v[28:31], a[112:115], v[20:23], v[28:31]
    s_waitcnt vmcnt(0)
    v_swap_b32 v170, v172
    v_swap_b32 v171, v173
    s_nop 0
    v_cvt_pk_bf16_f32 v44, v44, v45
    v_mfma_f32_16x16x32_bf16 v[24:27], a[112:115], v[168:171], v[24:27]
    ds_read_b64_tr_b16 a[194:195], v152 offset:14336
    ds_read_b64_tr_b16 a[196:197], v153 offset:12288
    v_mfma_f32_16x16x32_bf16 v[104:107], a[112:115], v[172:175], v[104:107]
    ds_read_b64_tr_b16 a[198:199], v153 offset:14336
    ds_read_b64_tr_b16 a[200:201], v154 offset:12288
    v_mfma_f32_16x16x32_bf16 v[240:243], a[84:87], v[112:115], v[240:243]
    ds_read_b64_tr_b16 a[202:203], v154 offset:14336
    ds_read_b64_tr_b16 a[204:205], v155 offset:12288
    v_mfma_f32_16x16x32_bf16 v[244:247], a[84:87], v[140:143], v[244:247]
    s_add_u32 m0, s1, 16384
    ds_read_b64_tr_b16 a[206:207], v155 offset:14336
    v_cvt_pk_bf16_f32 v45, v46, v47
    v_mfma_f32_16x16x32_bf16 v[200:203], a[84:87], v[120:123], v[200:203]
    s_waitcnt lgkmcnt(13)
    v_cvt_pk_bf16_f32 v46, v28, v29
    v_cvt_pk_bf16_f32 v47, v30, v31
    v_mfma_f32_16x16x32_bf16 v[204:207], a[84:87], v[208:211], v[204:207]
    s_lshl1_add_u32 s46, s43, 0
    ds_write_b128 v8, v[44:47] offset:5120
    v_mfma_f32_16x16x32_bf16 v[240:243], a[100:103], v[212:215], v[240:243]
    s_xor_b32 s46, s46, s41
    v_cvt_pk_bf16_f32 v24, v24, v25
    v_cvt_pk_bf16_f32 v25, v26, v27
    v_mfma_f32_16x16x32_bf16 v[244:247], a[100:103], v[64:67], v[244:247]
    s_mul_i32 s46, s46, 229376
    v_cvt_pk_bf16_f32 v26, v104, v105
    v_cvt_pk_bf16_f32 v27, v106, v107
    v_mfma_f32_16x16x32_bf16 v[200:203], a[100:103], v[68:71], v[200:203]
    s_add_u32 s46, s46, s45
    ds_write_b128 v8, v[24:27] offset:4096
    v_mfma_f32_16x16x32_bf16 v[204:207], a[100:103], v[96:99], v[204:207]
    s_lshl_b32 s55, s43, 16
    s_sub_u32 s46, s46, s55
    s_add_u32 s46, s46, 49152
    v_mfma_f32_16x16x32_bf16 v[240:243], a[116:119], v[100:103], v[240:243]
    buffer_load_dwordx4 v148, s[16:19], s46 offen offset:0 lds
    v_mfma_f32_16x16x32_bf16 v[244:247], a[116:119], v[20:23], v[244:247]
    v_xor_b32 v8, 16384, v8
    v_mfma_f32_16x16x32_bf16 v[200:203], a[116:119], v[168:171], v[200:203]
    v_cvt_pk_bf16_f32 v240, v240, v241
    v_cvt_pk_bf16_f32 v241, v242, v243
    v_mfma_f32_16x16x32_bf16 v[204:207], a[116:119], v[172:175], v[204:207]
    buffer_load_dwordx4 v149, s[16:19], s46 offen offset:1024 lds
    v_mfma_f32_16x16x32_bf16 v[56:59], a[88:91], v[112:115], v[56:59]
    s_lshl1_add_u32 s46, s43, 1
    v_cvt_pk_bf16_f32 v242, v244, v245
    v_cvt_pk_bf16_f32 v243, v246, v247
    v_mfma_f32_16x16x32_bf16 v[116:119], a[88:91], v[140:143], v[116:119]
    s_xor_b32 s46, s46, s41
    ds_write_b128 v8, v[240:243] offset:2048
    v_mfma_f32_16x16x32_bf16 v[60:63], a[88:91], v[120:123], v[60:63]
    s_mul_i32 s46, s46, 229376
    v_cvt_pk_bf16_f32 v200, v200, v201
    s_add_u32 s46, s46, s45
    v_mfma_f32_16x16x32_bf16 v[232:235], a[88:91], v[208:211], v[232:235]
    s_lshl_b32 s55, s43, 16
    s_sub_u32 s46, s46, s55
    s_add_u32 s46, s46, 47104
    v_mfma_f32_16x16x32_bf16 v[56:59], a[104:107], v[212:215], v[56:59]
    buffer_load_dwordx4 v148, s[16:19], s46 offen offset:2048 lds
    v_mfma_f32_16x16x32_bf16 v[116:119], a[104:107], v[64:67], v[116:119]
    v_cvt_pk_bf16_f32 v201, v202, v203
    v_cvt_pk_bf16_f32 v202, v204, v205
    v_mfma_f32_16x16x32_bf16 v[60:63], a[104:107], v[68:71], v[60:63]
    v_cvt_pk_bf16_f32 v203, v206, v207
    v_mfma_f32_16x16x32_bf16 v[232:235], a[104:107], v[96:99], v[232:235]
    ds_write_b128 v8, v[200:203] offset:3072
    v_mfma_f32_16x16x32_bf16 v[56:59], a[120:123], v[100:103], v[56:59]
    v_xor_b32 v8, 49152, v8
    v_mfma_f32_16x16x32_bf16 v[116:119], a[120:123], v[20:23], v[116:119]
    buffer_load_dwordx4 v149, s[16:19], s46 offen offset:3072 lds
    v_mfma_f32_16x16x32_bf16 v[60:63], a[120:123], v[168:171], v[60:63]
    v_cvt_pk_bf16_f32 v56, v56, v57
    v_cvt_pk_bf16_f32 v57, v58, v59
    v_mfma_f32_16x16x32_bf16 v[232:235], a[120:123], v[172:175], v[232:235]
    v_cvt_pk_bf16_f32 v58, v116, v117
    v_cvt_pk_bf16_f32 v59, v118, v119
L_pad5:
    s_cbranch_execz L_retB
    v_mfma_f32_16x16x32_bf16 v[32:35], a[92:95], v[112:115], v[32:35]
    ds_write_b128 v8, v[56:59] offset:1024
    v_mfma_f32_16x16x32_bf16 v[236:239], a[92:95], v[140:143], v[236:239]
    v_cvt_pk_bf16_f32 v60, v60, v61
    v_cvt_pk_bf16_f32 v61, v62, v63
    v_mfma_f32_16x16x32_bf16 v[192:195], a[92:95], v[120:123], v[192:195]
    v_cvt_pk_bf16_f32 v62, v232, v233
    v_cvt_pk_bf16_f32 v63, v234, v235
    v_mfma_f32_16x16x32_bf16 v[196:199], a[92:95], v[208:211], v[196:199]
    ds_write_b128 v8, v[60:63] offset:0
    v_mfma_f32_16x16x32_bf16 v[32:35], a[108:111], v[212:215], v[32:35]
    v_xor_b32 v8, 16384, v8
    v_mfma_f32_16x16x32_bf16 v[236:239], a[108:111], v[64:67], v[236:239]
    v_mfma_f32_16x16x32_bf16 v[192:195], a[108:111], v[68:71], v[192:195]
    v_mfma_f32_16x16x32_bf16 v[196:199], a[108:111], v[96:99], v[196:199]
    v_mfma_f32_16x16x32_bf16 v[32:35], a[124:127], v[100:103], v[32:35]
    v_mfma_f32_16x16x32_bf16 v[236:239], a[124:127], v[20:23], v[236:239]
    v_mfma_f32_16x16x32_bf16 v[192:195], a[124:127], v[168:171], v[192:195]
    v_mfma_f32_16x16x32_bf16 v[196:199], a[124:127], v[172:175], v[196:199]
    s_waitcnt vmcnt(0)
    ds_read_b64_tr_b16 a[208:209], v152 offset:16384
    ds_read_b64_tr_b16 a[210:211], v152 offset:18432
    ds_read_b64_tr_b16 a[212:213], v153 offset:16384
    ds_read_b64_tr_b16 a[214:215], v153 offset:18432
    ds_read_b64_tr_b16 a[216:217], v154 offset:16384
    ds_read_b64_tr_b16 a[218:219], v154 offset:18432
    ds_read_b64_tr_b16 a[220:221], v155 offset:16384
    ds_read_b64_tr_b16 a[222:223], v155 offset:18432
    s_waitcnt lgkmcnt(0)
    s_barrier
    v_mfma_f32_16x16x32_bf16 v[216:219], a[128:131], a[224:227], v[216:219]
    ds_read_b128 a[48:51], v8 offset:4096
    ds_read_b128 a[52:55], v8 offset:5120
    v_mfma_f32_16x16x32_bf16 v[220:223], a[128:131], a[228:231], v[220:223]
    ds_read_b128 a[32:35], v8 offset:0
    v_mfma_f32_16x16x32_bf16 v[48:51], a[128:131], a[232:235], v[48:51]
    ds_read_b128 a[36:39], v8 offset:2048
    v_mfma_f32_16x16x32_bf16 v[52:55], a[128:131], a[236:239], v[52:55]
    ds_read_b128 a[40:43], v8 offset:1024
    v_mfma_f32_16x16x32_bf16 v[216:219], a[144:147], a[240:243], v[216:219]
    ds_read_b128 a[44:47], v8 offset:3072
    v_xor_b32 v8, 114688, v8
    v_mfma_f32_16x16x32_bf16 v[220:223], a[144:147], a[244:247], v[220:223]
    s_waitcnt lgkmcnt(5)
    v_mfma_f32_16x16x32_bf16 v[32:35], v[178:181], a[48:51], v[32:35]
    s_waitcnt lgkmcnt(4)
    v_mfma_f32_16x16x32_bf16 v[236:239], v[176:179], a[48:51], v[236:239]
    v_mfma_f32_16x16x32_bf16 v[192:195], v[178:181], a[52:55], v[192:195]
    s_waitcnt lgkmcnt(2)
    v_mfma_f32_16x16x32_bf16 v[196:199], v[176:179], a[52:55], v[196:199]
    v_smfmac_f32_16x16x64_bf16 v[32:35], v[156:159], a[32:39], v191
    s_waitcnt lgkmcnt(0)
    v_smfmac_f32_16x16x64_bf16 v[236:239], v[10:13], a[32:39], v191
    v_smfmac_f32_16x16x64_bf16 v[192:195], v[156:159], a[40:47], v191
    s_nop 0
    v_cvt_pk_bf16_f32 v32, v32, v33
    v_smfmac_f32_16x16x64_bf16 v[196:199], v[10:13], a[40:47], v191
    v_cvt_pk_bf16_f32 v33, v34, v35
    v_mfma_f32_16x16x32_bf16 v[48:51], a[144:147], a[248:251], v[48:51]
    ds_read_u16_d16_hi v124, v160 offset:0
    v_mfma_f32_16x16x32_bf16 v[52:55], a[144:147], a[252:255], v[52:55]
    s_nop 0
    v_cvt_pk_bf16_f32 v34, v196, v197
    v_mov_b32 v35, s100
    v_mfma_f32_16x16x32_bf16 v[216:219], a[160:163], a[0:3], v[216:219]
    v_cvt_pk_bf16_f32 v236, v236, v237
    v_cvt_pk_bf16_f32 v237, v238, v239
    v_mfma_f32_16x16x32_bf16 v[220:223], a[160:163], a[4:7], v[220:223]
    v_cvt_pk_bf16_f32 v238, v198, v199
    v_mov_b32 v239, s100
    v_mfma_f32_16x16x32_bf16 v[48:51], a[160:163], a[8:11], v[48:51]
    s_xor_b32 s53, s52, 270336
    v_cvt_pk_bf16_f32 v192, v192, v193
    v_cvt_pk_bf16_f32 v193, v194, v195
    v_mfma_f32_16x16x32_bf16 v[52:55], a[160:163], a[12:15], v[52:55]
    buffer_store_dwordx4 v[32:35], v3, s[24:27], s53 offen offset:0 sc1
    v_mfma_f32_16x16x32_bf16 v[216:219], a[176:179], v[112:115], v[216:219]
    buffer_store_dwordx4 v[236:239], v3, s[24:27], s53 offen offset:1024 sc1
    v_mfma_f32_16x16x32_bf16 v[220:223], a[176:179], v[140:143], v[220:223]
    v_mov_b32 v194, s100
    v_mov_b32 v195, s100
    v_mfma_f32_16x16x32_bf16 v[48:51], a[176:179], v[120:123], v[48:51]
    buffer_store_dwordx4 v[192:195], v3, s[24:27], s53 offen offset:2048 sc1
    v_mfma_f32_16x16x32_bf16 v[52:55], a[176:179], v[208:211], v[52:55]
    ds_read_u16_d16_hi v125, v161 offset:0
    v_mfma_f32_16x16x32_bf16 v[216:219], a[192:195], v[212:215], v[216:219]
    v_mfma_f32_16x16x32_bf16 v[220:223], a[192:195], v[64:67], v[220:223]
    v_mfma_f32_16x16x32_bf16 v[48:51], a[192:195], v[68:71], v[48:51]
    v_mfma_f32_16x16x32_bf16 v[52:55], a[192:195], v[96:99], v[52:55]
    v_mfma_f32_16x16x32_bf16 v[216:219], a[208:211], v[100:103], v[216:219]
    v_mfma_f32_16x16x32_bf16 v[220:223], a[208:211], v[20:23], v[220:223]
    v_mfma_f32_16x16x32_bf16 v[48:51], a[208:211], v[168:171], v[48:51]
    v_cvt_pk_bf16_f32 v216, v216, v217
    v_cvt_pk_bf16_f32 v217, v218, v219
    v_mfma_f32_16x16x32_bf16 v[52:55], a[208:211], v[172:175], v[52:55]
    v_cvt_pk_bf16_f32 v218, v220, v221
    v_cvt_pk_bf16_f32 v219, v222, v223
    v_mfma_f32_16x16x32_bf16 v[16:19], a[132:135], a[224:227], v[16:19]
    v_cvt_pk_bf16_f32 v48, v48, v49
    v_cvt_pk_bf16_f32 v49, v50, v51
    v_mfma_f32_16x16x32_bf16 v[132:135], a[132:135], a[228:231], v[132:135]
    ds_read_u16_d16_hi v126, v162 offset:0
    ds_read_u16_d16_hi v127, v163 offset:0
    v_mfma_f32_16x16x32_bf16 v[128:131], a[132:135], a[232:235], v[128:131]
    ds_read_u16_d16_hi v80, v160 offset:1024
    ds_read_u16_d16_hi v81, v161 offset:1024
    v_mfma_f32_16x16x32_bf16 v[248:251], a[132:135], a[236:239], v[248:251]
    ds_read_u16_d16_hi v82, v162 offset:1024
    v_cvt_pk_bf16_f32 v50, v52, v53
    v_mfma_f32_16x16x32_bf16 v[16:19], a[148:151], a[240:243], v[16:19]
    ds_write_b128 v8, v[216:219] offset:5120
    v_mfma_f32_16x16x32_bf16 v[132:135], a[148:151], a[244:247], v[132:135]
    v_cvt_pk_bf16_f32 v51, v54, v55
    v_mfma_f32_16x16x32_bf16 v[128:131], a[148:151], a[248:251], v[128:131]
    v_mfma_f32_16x16x32_bf16 v[248:251], a[148:151], a[252:255], v[248:251]
    ds_write_b128 v8, v[48:51] offset:4096
    v_mfma_f32_16x16x32_bf16 v[16:19], a[164:167], a[0:3], v[16:19]
    v_xor_b32 v8, 16384, v8
    v_xor_b32 v160, 2048, v160
    v_mfma_f32_16x16x32_bf16 v[132:135], a[164:167], a[4:7], v[132:135]
    ds_read_u16_d16_hi v83, v163 offset:1024
    ds_read_u16_d16_hi v84, v160 offset:0
    v_mfma_f32_16x16x32_bf16 v[128:131], a[164:167], a[8:11], v[128:131]
    v_xor_b32 v161, 2048, v161
    v_xor_b32 v162, 2048, v162
    v_mfma_f32_16x16x32_bf16 v[248:251], a[164:167], a[12:15], v[248:251]
    ds_read_u16_d16_hi v85, v161 offset:0
    ds_read_u16_d16_hi v86, v162 offset:0
    v_mfma_f32_16x16x32_bf16 v[16:19], a[180:183], v[112:115], v[16:19]
    v_xor_b32 v163, 2048, v163
    v_lshlrev_b32 v184, 16, v182
    v_mfma_f32_16x16x32_bf16 v[132:135], a[180:183], v[140:143], v[132:135]
    ds_read_u16_d16_hi v87, v163 offset:0
    ds_read_u16_d16_hi v88, v160 offset:1024
    v_mfma_f32_16x16x32_bf16 v[128:131], a[180:183], v[120:123], v[128:131]
    ds_read_u16_d16_hi v89, v161 offset:1024
    ds_read_u16_d16_hi v90, v162 offset:1024
    v_mfma_f32_16x16x32_bf16 v[248:251], a[180:183], v[208:211], v[248:251]
    ds_read_u16_d16_hi v91, v163 offset:1024
    v_and_b32 v185, 0xffff0000, v182
    v_mfma_f32_16x16x32_bf16 v[16:19], a[196:199], v[212:215], v[16:19]
    v_lshlrev_b32 v186, 16, v183
    v_mfma_f32_16x16x32_bf16 v[132:135], a[196:199], v[64:67], v[132:135]
    v_mfma_f32_16x16x32_bf16 v[128:131], a[196:199], v[68:71], v[128:131]
    v_mfma_f32_16x16x32_bf16 v[248:251], a[196:199], v[96:99], v[248:251]
    v_and_b32 v187, 0xffff0000, v183
    s_waitcnt lgkmcnt(0)
    v_mfma_f32_16x16x32_bf16 v[16:19], a[212:215], v[100:103], v[16:19]
    v_and_b32 v124, 0xffff0000, v124
    v_and_b32 v125, 0xffff0000, v125
    v_mfma_f32_16x16x32_bf16 v[132:135], a[212:215], v[20:23], v[132:135]
    v_and_b32 v126, 0xffff0000, v126
    v_and_b32 v127, 0xffff0000, v127
    v_mfma_f32_16x16x32_bf16 v[128:131], a[212:215], v[168:171], v[128:131]
    v_and_b32 v80, 0xffff0000, v80
    v_and_b32 v81, 0xffff0000, v81
    v_mfma_f32_16x16x32_bf16 v[248:251], a[212:215], v[172:175], v[248:251]
    v_and_b32 v82, 0xffff0000, v82
    v_and_b32 v83, 0xffff0000, v83
    v_mfma_f32_16x16x32_bf16 v[252:255], a[136:139], a[224:227], v[252:255]
    v_and_b32 v84, 0xffff0000, v84
    v_and_b32 v85, 0xffff0000, v85
    v_mfma_f32_16x16x32_bf16 v[72:75], a[136:139], a[228:231], v[72:75]
    v_and_b32 v86, 0xffff0000, v86
    v_and_b32 v87, 0xffff0000, v87
    v_mfma_f32_16x16x32_bf16 v[76:79], a[136:139], a[232:235], v[76:79]
    v_and_b32 v88, 0xffff0000, v88
    v_and_b32 v89, 0xffff0000, v89
    v_mfma_f32_16x16x32_bf16 v[224:227], a[136:139], a[236:239], v[224:227]
    v_and_b32 v90, 0xffff0000, v90
    v_and_b32 v91, 0xffff0000, v91
    v_mfma_f32_16x16x32_bf16 v[252:255], a[152:155], a[240:243], v[252:255]
    v_add_f32 v124, v124, v184
    v_add_f32 v125, v125, v185
    v_mfma_f32_16x16x32_bf16 v[72:75], a[152:155], a[244:247], v[72:75]
    v_cvt_pk_bf16_f32 v16, v16, v17
    v_cvt_pk_bf16_f32 v17, v18, v19
    v_mfma_f32_16x16x32_bf16 v[76:79], a[152:155], a[248:251], v[76:79]
    v_cvt_pk_bf16_f32 v18, v132, v133
    v_cvt_pk_bf16_f32 v19, v134, v135
    v_mfma_f32_16x16x32_bf16 v[224:227], a[152:155], a[252:255], v[224:227]
    ds_write_b128 v8, v[16:19] offset:2048
    v_mfma_f32_16x16x32_bf16 v[252:255], a[168:171], a[0:3], v[252:255]
    v_cvt_pk_bf16_f32 v128, v128, v129
    v_cvt_pk_bf16_f32 v129, v130, v131
    v_mfma_f32_16x16x32_bf16 v[72:75], a[168:171], a[4:7], v[72:75]
    v_cvt_pk_bf16_f32 v130, v248, v249
    v_cvt_pk_bf16_f32 v131, v250, v251
    v_mfma_f32_16x16x32_bf16 v[76:79], a[168:171], a[8:11], v[76:79]
    ds_write_b128 v8, v[128:131] offset:3072
    v_mfma_f32_16x16x32_bf16 v[224:227], a[168:171], a[12:15], v[224:227]
    v_xor_b32 v8, 49152, v8
    v_add_f32 v126, v126, v186
    v_mfma_f32_16x16x32_bf16 v[252:255], a[184:187], v[112:115], v[252:255]
    v_add_f32 v127, v127, v187
    v_add_f32 v80, v80, v184
    v_mfma_f32_16x16x32_bf16 v[72:75], a[184:187], v[140:143], v[72:75]
    s_add_u32 s53, s52, 8192
    v_add_f32 v81, v81, v185
    v_add_f32 v82, v82, v186
    v_mfma_f32_16x16x32_bf16 v[76:79], a[184:187], v[120:123], v[76:79]
    v_add_f32 v83, v83, v187
    v_add_f32 v84, v84, v184
    v_mfma_f32_16x16x32_bf16 v[224:227], a[184:187], v[208:211], v[224:227]
    v_add_f32 v85, v85, v185
    v_add_f32 v86, v86, v186
    v_mfma_f32_16x16x32_bf16 v[252:255], a[200:203], v[212:215], v[252:255]
    v_add_f32 v87, v87, v187
    v_add_f32 v88, v88, v184
    v_mfma_f32_16x16x32_bf16 v[72:75], a[200:203], v[64:67], v[72:75]
    v_add_f32 v89, v89, v185
    v_add_f32 v90, v90, v186
    v_mfma_f32_16x16x32_bf16 v[76:79], a[200:203], v[68:71], v[76:79]
    v_add_f32 v91, v91, v187
    v_mfma_f32_16x16x32_bf16 v[224:227], a[200:203], v[96:99], v[224:227]
    v_mfma_f32_16x16x32_bf16 v[252:255], a[216:219], v[100:103], v[252:255]
    v_mfma_f32_16x16x32_bf16 v[72:75], a[216:219], v[20:23], v[72:75]
    v_mfma_f32_16x16x32_bf16 v[76:79], a[216:219], v[168:171], v[76:79]
    v_cvt_pk_bf16_f32 v252, v252, v253
    v_cvt_pk_bf16_f32 v253, v254, v255
    v_mfma_f32_16x16x32_bf16 v[224:227], a[216:219], v[172:175], v[224:227]
    v_cvt_pk_bf16_f32 v254, v72, v73
    v_cvt_pk_bf16_f32 v255, v74, v75
    v_mfma_f32_16x16x32_bf16 v[108:111], a[140:143], a[224:227], v[108:111]
    ds_write_b128 v8, v[252:255] offset:1024
    v_mfma_f32_16x16x32_bf16 v[228:231], a[140:143], a[228:231], v[228:231]
    buffer_load_dwordx4 v[28:31], v3, s[24:27], s53 offen offset:0 sc1
    v_mfma_f32_16x16x32_bf16 v[136:139], a[140:143], a[232:235], v[136:139]
    buffer_load_dwordx4 v[32:35], v3, s[24:27], s53 offen offset:1024 sc1
    v_mfma_f32_16x16x32_bf16 v[36:39], a[140:143], a[236:239], v[36:39]
    buffer_load_dwordx4 v[92:95], v3, s[24:27], s53 offen offset:2048 sc1
    v_mfma_f32_16x16x32_bf16 v[108:111], a[156:159], a[240:243], v[108:111]
    v_cvt_pk_bf16_f32 v76, v76, v77
    v_cvt_pk_bf16_f32 v77, v78, v79
    v_mfma_f32_16x16x32_bf16 v[228:231], a[156:159], a[244:247], v[228:231]
    v_cvt_pk_bf16_f32 v78, v224, v225
    v_cvt_pk_bf16_f32 v79, v226, v227
    v_mfma_f32_16x16x32_bf16 v[136:139], a[156:159], a[248:251], v[136:139]
    ds_write_b128 v8, v[76:79] offset:0
    v_mfma_f32_16x16x32_bf16 v[36:39], a[156:159], a[252:255], v[36:39]
    v_xor_b32 v8, 16384, v8
    v_mfma_f32_16x16x32_bf16 v[108:111], a[172:175], a[0:3], v[108:111]
    v_mfma_f32_16x16x32_bf16 v[228:231], a[172:175], a[4:7], v[228:231]
    v_mfma_f32_16x16x32_bf16 v[136:139], a[172:175], a[8:11], v[136:139]
    s_waitcnt lgkmcnt(0)
    v_mfma_f32_16x16x32_bf16 v[36:39], a[172:175], a[12:15], v[36:39]
    s_barrier
    ds_read_b128 a[72:75], v8 offset:4096
    ds_read_b128 a[76:79], v8 offset:5120
    v_mfma_f32_16x16x32_bf16 v[108:111], a[188:191], v[112:115], v[108:111]
    ds_read_b128 a[56:59], v8 offset:0
    v_mfma_f32_16x16x32_bf16 v[228:231], a[188:191], v[140:143], v[228:231]
    ds_read_b128 a[60:63], v8 offset:2048
    v_mfma_f32_16x16x32_bf16 v[136:139], a[188:191], v[120:123], v[136:139]
    ds_read_b128 a[64:67], v8 offset:1024
    v_mfma_f32_16x16x32_bf16 v[36:39], a[188:191], v[208:211], v[36:39]
    ds_read_b128 a[68:71], v8 offset:3072
    v_mfma_f32_16x16x32_bf16 v[108:111], a[204:207], v[212:215], v[108:111]
    s_waitcnt lgkmcnt(5)
    v_mfma_f32_16x16x32_bf16 v[228:231], a[204:207], v[64:67], v[228:231]
    s_waitcnt lgkmcnt(4)
    v_mfma_f32_16x16x32_bf16 v[136:139], a[204:207], v[68:71], v[136:139]
    v_mfma_f32_16x16x32_bf16 v[36:39], a[204:207], v[96:99], v[36:39]
    s_waitcnt lgkmcnt(2)
    v_mfma_f32_16x16x32_bf16 v[108:111], v[178:181], a[72:75], v[108:111]
    v_mfma_f32_16x16x32_bf16 v[228:231], v[176:179], a[72:75], v[228:231]
    s_waitcnt lgkmcnt(0)
    v_mfma_f32_16x16x32_bf16 v[136:139], v[178:181], a[76:79], v[136:139]
    v_mfma_f32_16x16x32_bf16 v[36:39], v[176:179], a[76:79], v[36:39]
    v_smfmac_f32_16x16x64_bf16 v[108:111], v[156:159], a[56:63], v191
    v_smfmac_f32_16x16x64_bf16 v[228:231], v[10:13], a[56:63], v191
    v_smfmac_f32_16x16x64_bf16 v[136:139], v[156:159], a[64:71], v191
    v_smfmac_f32_16x16x64_bf16 v[36:39], v[10:13], a[64:71], v191
    v_mfma_f32_16x16x32_bf16 v[108:111], a[220:223], v[100:103], v[108:111]
    v_mfma_f32_16x16x32_bf16 v[228:231], a[220:223], v[20:23], v[228:231]
    v_mfma_f32_16x16x32_bf16 v[136:139], a[220:223], v[168:171], v[136:139]
    v_mfma_f32_16x16x32_bf16 v[36:39], a[220:223], v[172:175], v[36:39]
    s_movk_i32 s36, 0x4000
    s_waitcnt vmcnt(0)
L_chk_10:
    v_xor_b32 v14, s100, v31
    v_bitop3_b32 v14, v14, v35, s100 bitop3:0xf6
    v_bitop3_b32 v14, v14, v95, s100 bitop3:0xf6
    v_cmp_ne_u32 vcc, 0, v14
    s_cbranch_vccz L_got_11
    s_add_u32 s53, s52, 8192
    buffer_load_dwordx4 v[28:31], v3, s[24:27], s53 offen offset:0 sc1
    buffer_load_dwordx4 v[32:35], v3, s[24:27], s53 offen offset:1024 sc1
    buffer_load_dwordx4 v[92:95], v3, s[24:27], s53 offen offset:2048 sc1
    s_sub_u32 s36, s36, 1
    s_waitcnt vmcnt(0)
    s_cbranch_scc0 L_chk_10
L_got_11:
    v_mfma_f32_16x16x32_bf16 v[108:111], v[178:181], v[28:31], v[108:111]
    v_mfma_f32_16x16x32_bf16 v[228:231], v[178:181], v[32:35], v[228:231]
    v_mfma_f32_16x16x32_bf16 v[136:139], v[178:181], v[92:95], v[136:139]
    v_fma_f32 v108, v108, v40, v124
    v_fma_f32 v109, v109, v40, v125
    v_fma_f32 v110, v110, v40, v126
    v_smfmac_f32_16x16x64_bf16 v[36:39], v[144:147], v[28:35], v191 abid:1
    v_fma_f32 v111, v111, v40, v127
    v_cvt_pk_bf16_f32 v108, v108, v109
    v_cvt_pk_bf16_f32 v109, v110, v111
    v_pk_fma_f32 v[228:229], v[228:229], v[40:41], v[80:81] op_sel:[0,1,0] op_sel_hi:[1,1,1]
    v_pk_fma_f32 v[230:231], v[230:231], v[40:41], v[82:83] op_sel:[0,1,0] op_sel_hi:[1,1,1]
    v_cvt_pk_bf16_f32 v110, v228, v229
    v_cvt_pk_bf16_f32 v111, v230, v231
    v_pk_fma_f32 v[136:137], v[136:137], v[42:43], v[84:85] op_sel:[0,0,0] op_sel_hi:[1,0,1]
    v_pk_fma_f32 v[138:139], v[138:139], v[42:43], v[86:87] op_sel:[0,0,0] op_sel_hi:[1,0,1]
    v_permlane16_swap_b32 v108, v110
    v_permlane16_swap_b32 v109, v111
    v_cvt_pk_bf16_f32 v136, v136, v137
    v_cvt_pk_bf16_f32 v137, v138, v139
    v_pk_fma_f32 v[36:37], v[36:37], v[42:43], v[88:89] op_sel:[0,1,0] op_sel_hi:[1,1,1]
    v_pk_fma_f32 v[38:39], v[38:39], v[42:43], v[90:91] op_sel:[0,1,0] op_sel_hi:[1,1,1]
    v_cvt_pk_bf16_f32 v138, v36, v37
    v_cvt_pk_bf16_f32 v139, v38, v39
    buffer_store_dwordx4 v[108:111], v164, s[20:23], 0 offen
    v_permlane16_swap_b32 v136, v138
    v_permlane16_swap_b32 v137, v139
    buffer_store_dwordx4 v[136:139], v165, s[20:23], 0 offen
L_end:
    s_endpgm
.section .rodata,"a"
.p2align 6
.amdhsa_kernel sequential_preLN__spectral_fnet__dense_activation_squared_relu__prompt_kernel
  .amdhsa_next_free_vgpr 512
  .amdhsa_next_free_sgpr 102
  .amdhsa_accum_offset 256
  .amdhsa_group_segment_fixed_size 0
  .amdhsa_kernarg_size 104
  .amdhsa_user_sgpr_count 2
  .amdhsa_user_sgpr_kernarg_segment_ptr 1
  .amdhsa_system_sgpr_workgroup_id_x 1
.end_amdhsa_kernel
```
